```python
import torch

def _softmax(x, axis=-1):
    return torch.softmax(x, dim=axis)
def _gelu(x):
    return torch.nn.functional.gelu(x, approximate="tanh")
def _silu(x):
    return torch.nn.functional.silu(x)
def _sigmoid(x):
    return torch.sigmoid(x)
def _layernorm(x, axis=-1, eps=1e-5):
    m = x.mean(dim=axis, keepdim=True)
    v = x.var(dim=axis, keepdim=True, unbiased=False)
    return (x - m) / torch.sqrt(v + eps)
def _scatter_add(tgt, idx, src, axis=0):
    return tgt.clone().index_add_(axis, idx, src)
def _segment_sum(src, seg, n):
    out = torch.zeros((n,) + src.shape[1:], dtype=src.dtype)
    return out.index_add_(0, seg, src)
def _pad(x, pw):
    flat = tuple(v for pair in reversed(pw) for v in pair)
    return torch.nn.functional.pad(x, flat)

kernel_name = 'concat_heads__sliding_block__grouped_kv_mqa__prompt'

def setup_inputs():

    _w = (lambda a: (lambda t: t.to(torch.bfloat16) if t.is_floating_point() else t)(torch.as_tensor(a)))
    def _A_setup():
        B, S, D = 1, 2048, 640
        return {
            "x": _w((lambda *s: torch.randn(*s, dtype=torch.bfloat16) * 0.2)(B, S, D)),
            "wqkv": _w((lambda *s: torch.randn(*s, dtype=torch.bfloat16) * 0.8)(D, 3 * D)),
            "wo": _w((lambda *s: torch.randn(*s, dtype=torch.bfloat16) * 0.4)(D, D)),
        }
    _A_in = _A_setup()

    def _B_setup():
        B, S, D, H = 1, 2048, 640, 32
        Dh = D // H
        return {
            "x": _w((lambda *s: torch.randn(*s, dtype=torch.bfloat16) * 0.1)(B, S, D)),
            "wq": _w((lambda *s: torch.randn(*s, dtype=torch.bfloat16) * 0.8)(D, H * Dh)),
            "wk": _w((lambda *s: torch.randn(*s, dtype=torch.bfloat16) * 0.8)(D, Dh)),
            "wv": _w((lambda *s: torch.randn(*s, dtype=torch.bfloat16) * 0.8)(D, Dh)),
            "wo": _w((lambda *s: torch.randn(*s, dtype=torch.bfloat16) * 0.8)(H * Dh, D)),
        }
    _B_in = _B_setup()

    return {
        "A_x": _A_in["x"],
        "A_wqkv": _A_in["wqkv"],
        "A_wo": _A_in["wo"],
        "B_x": _B_in["x"],
        "B_wq": _B_in["wq"],
        "B_wk": _B_in["wk"],
        "B_wv": _B_in["wv"],
        "B_wo": _B_in["wo"],
    }

def reference(A_x, A_wqkv, A_wo, B_x, B_wq, B_wk, B_wv, B_wo):
    def _A_ref(x, wqkv, wo):
        B, S, D = x.shape
        H = 32; Dh = D // H; W = 256
        qkv = (lambda x, *d: x.permute(*d))((x @ wqkv).reshape(B, S, 3, H, Dh), 2, 0, 3, 1, 4)
        q, k, v = qkv[0], qkv[1], qkv[2]
        scores = torch.einsum("bhqd,bhkd->bhqk", q, k) * (Dh ** -0.5)
        idx = torch.arange(S)
        mask = (idx[:, None] - idx[None, :] >= 0) & (idx[:, None] - idx[None, :] < W)
        scores = torch.where(mask[None, None], scores, -1e9)
        p = _softmax(scores, axis=-1)
        o = torch.einsum("bhqk,bhkd->bhqd", p, v)
        return (lambda x, *d: x.permute(*d))(o, 0, 2, 1, 3).reshape(B, S, D) @ wo

    def _B_ref(x, wq, wk, wv, wo):
        B, S, D = x.shape
        H = 32
        Dh = D // H
        q = (lambda x, *d: x.permute(*d))((x @ wq).reshape(B, S, H, Dh), 0, 2, 1, 3)
        k = x @ wk
        v = x @ wv
        scores = torch.einsum("bhqd,bkd->bhqk", q, k) * (Dh ** -0.5)
        p = _softmax(scores, axis=-1)
        o = torch.einsum("bhqk,bkd->bhqd", p, v)
        return (lambda x, *d: x.permute(*d))(o, 0, 2, 1, 3).reshape(B, S, H * Dh) @ wo

    a = _A_ref(A_x, A_wqkv, A_wo)
    b = _B_ref(B_x, B_wq, B_wk, B_wv, B_wo)
    return torch.concatenate([a, b], axis=-1)
```

```asm
; @launch grid=(256,1,1) block=(512,1,1) lds=163840
.amdgcn_target "amdgcn-amd-amdhsa--gfx950"
.text
.globl concat_heads__sliding_block__grouped_kv_mqa__prompt_kernel
.p2align 8
.type concat_heads__sliding_block__grouped_kv_mqa__prompt_kernel,@function
concat_heads__sliding_block__grouped_kv_mqa__prompt_kernel:
    s_cmp_ge_u32 s2, 256
    s_cbranch_scc1 concat_heads__sliding_block__grouped_kv_mqa__prompt_kernel_end
    s_load_dwordx8 s[40:47], s[0:1], 0
    s_load_dwordx8 s[48:55], s[0:1], 32
    s_load_dwordx4 s[56:59], s[0:1], 64
    s_load_dwordx2 s[20:21], s[0:1], 80
    v_lshrrev_b32 v1, 6, v0
    v_and_b32 v0, 63, v0
    s_mov_b32 s37, s2
    v_readfirstlane_b32 s36, v1
    s_bfe_u32 s38, s2, 0x20003
    s_and_b32 s39, s2, 1
    s_lshl_b32 s39, s39, 3
    s_lshr_b32 s3, s2, 5
    s_add_u32 s39, s39, s3
    s_bfe_u32 s92, s2, 0x20001
    s_lshl_b32 s93, s2, 7
    s_add_u32 s93, s93, 13815808
    v_lshlrev_b32 v2, 4, v0
    s_cmp_eq_u32 s38, 3
    s_cbranch_scc1 concat_heads__sliding_block__grouped_kv_mqa__prompt_kernel_t3
    s_cmp_ge_u32 s36, 4
    s_cbranch_scc0 concat_heads__sliding_block__grouped_kv_mqa__prompt_kernel_csetup
    s_setprio 3
    s_sub_u32 s3, s36, 4
    s_cmp_eq_u32 s38, 2
    s_cselect_b64 s[60:61], -1, 0
    v_lshrrev_b32 v7, 3, v0
    v_lshrrev_b32 v8, 4, v0
    v_xor_b32 v8, v8, v0
    v_and_b32 v8, 7, v8
    v_lshlrev_b32 v8, 4, v8
    v_and_b32 v10, 3, v7
    v_lshrrev_b32 v11, 5, v0
    v_lshl_add_u32 v10, v11, 3, v10
    v_cndmask_b32 v7, v7, v10, s[60:61]
    s_lshl_b32 s2, s39, 2
    s_add_u32 s2, s2, s3
    s_lshl_b32 s2, s2, 5
    v_add_u32 v7, s2, v7
    v_mul_u32_u24 v7, 1280, v7
    v_add_u32 v76, v7, v8
    s_and_b32 s2, s60, 10240
    s_add_u32 s2, s2, 10240
    v_xor_b32 v77, 64, v76
    v_add_u32 v77, s2, v77
    s_and_b32 s2, s60, 15360
    s_sub_u32 s2, 20480, s2
    v_add_u32 v78, s2, v76
    v_add_u32 v79, s2, v77
    s_lshl_b32 s2, s3, 12
    s_add_u32 m0, s2, 73728
    s_mov_b32 s6, 2621440
    s_mov_b32 s7, 0x00020000
    s_waitcnt lgkmcnt(0)
    s_mov_b64 s[4:5], s[40:41]
    buffer_load_dwordx4 v76, s[4:7], 0 offen lds
    s_add_u32 m0, m0, 1024
    s_nop 0
    buffer_load_dwordx4 v77, s[4:7], 0 offen lds
    s_add_u32 m0, m0, 1024
    s_nop 0
    buffer_load_dwordx4 v78, s[4:7], 0 offen lds
    s_add_u32 m0, m0, 1024
    s_nop 0
    buffer_load_dwordx4 v79, s[4:7], 0 offen lds
    s_lshl_b32 s2, s3, 4
    v_add_u32 v7, 0, v0
    v_mul_u32_u24 v8, 3277, v7
    v_lshrrev_b32 v8, 16, v8
    v_mul_u32_u24 v10, 20, v8
    v_sub_u32 v7, v7, v10
    v_lshrrev_b32 v10, 2, v8
    v_and_b32 v10, 2, v10
    v_sub_u32 v7, v7, v10
    v_add_u32 v10, 20, v7
    v_min_u32 v7, v7, v10
    v_add_u32 v8, s2, v8
    v_mul_u32_u24 v8, 3840, v8
    v_lshl_add_u32 v80, v7, 4, v8
    v_add_u32 v7, 64, v0
    v_mul_u32_u24 v8, 3277, v7
    v_lshrrev_b32 v8, 16, v8
    v_mul_u32_u24 v10, 20, v8
    v_sub_u32 v7, v7, v10
    v_lshrrev_b32 v10, 2, v8
    v_and_b32 v10, 2, v10
    v_sub_u32 v7, v7, v10
    v_add_u32 v10, 20, v7
    v_min_u32 v7, v7, v10
    v_add_u32 v8, s2, v8
    v_mul_u32_u24 v8, 3840, v8
    v_lshl_add_u32 v81, v7, 4, v8
    v_add_u32 v7, 128, v0
    v_mul_u32_u24 v8, 3277, v7
    v_lshrrev_b32 v8, 16, v8
    v_mul_u32_u24 v10, 20, v8
    v_sub_u32 v7, v7, v10
    v_lshrrev_b32 v10, 2, v8
    v_and_b32 v10, 2, v10
    v_sub_u32 v7, v7, v10
    v_add_u32 v10, 20, v7
    v_min_u32 v7, v7, v10
    v_add_u32 v8, s2, v8
    v_mul_u32_u24 v8, 3840, v8
    v_lshl_add_u32 v82, v7, 4, v8
    v_add_u32 v7, 192, v0
    v_mul_u32_u24 v8, 3277, v7
    v_lshrrev_b32 v8, 16, v8
    v_mul_u32_u24 v10, 20, v8
    v_sub_u32 v7, v7, v10
    v_lshrrev_b32 v10, 2, v8
    v_and_b32 v10, 2, v10
    v_sub_u32 v7, v7, v10
    v_add_u32 v10, 20, v7
    v_min_u32 v7, v7, v10
    v_add_u32 v8, s2, v8
    v_mul_u32_u24 v8, 3840, v8
    v_lshl_add_u32 v83, v7, 4, v8
    v_add_u32 v7, 256, v0
    v_mul_u32_u24 v8, 3277, v7
    v_lshrrev_b32 v8, 16, v8
    v_mul_u32_u24 v10, 20, v8
    v_sub_u32 v7, v7, v10
    v_lshrrev_b32 v10, 2, v8
    v_and_b32 v10, 2, v10
    v_sub_u32 v7, v7, v10
    v_add_u32 v10, 20, v7
    v_min_u32 v7, v7, v10
    v_add_u32 v8, s2, v8
    v_mul_u32_u24 v8, 3840, v8
    v_lshl_add_u32 v84, v7, 4, v8
    s_mov_b32 s14, 2621440
    s_mov_b32 s15, 0x00020000
    s_mov_b32 s18, 819200
    s_mov_b32 s19, 0x00020000
    s_mov_b32 s22, 13848576
    s_mov_b32 s23, 0x00020000
    s_mov_b32 s26, 819200
    s_mov_b32 s27, 0x00020000
    s_mov_b32 s30, 5242880
    s_mov_b32 s31, 0x00020000
    s_mov_b32 s34, 256
    s_mov_b32 s35, 0x00020000
    s_mov_b32 s7, 0x00020000
    s_mov_b32 s11, 0x00020000
    s_cmp_eq_u32 s38, 3
    s_cselect_b32 s6, 0, 2595840
    s_cselect_b32 s10, 0, 2432000
    s_add_u32 s6, s6, 25600
    s_add_u32 s10, s10, 25600
    s_cmp_eq_u32 s38, 3
    s_waitcnt lgkmcnt(0)
    s_cselect_b32 s4, s50, s40
    s_cselect_b32 s5, s51, s41
    s_cselect_b32 s8, s52, s42
    s_cselect_b32 s9, s53, s43
    s_mov_b64 s[12:13], s[46:47]
    s_mov_b64 s[16:17], s[48:49]
    s_bitcmp1_b32 s37, 0
    s_cselect_b32 s24, s54, s44
    s_cselect_b32 s25, s55, s45
    s_mov_b64 s[28:29], s[56:57]
    s_mov_b64 s[32:33], s[58:59]
    s_mov_b32 s40, s3
    s_mov_b32 s41, 0
    s_mul_i32 s42, s38, 1280
    s_mul_i32 s2, s92, 320
    s_add_u32 s42, s42, s2
    s_mov_b32 s43, 73728
    s_lshl_b32 s44, s40, 12
    s_mul_i32 s45, s40, 5120
    s_add_u32 s45, s45, 16384
    s_mov_b32 s46, 0
    s_add_u32 m0, s45, s43
    v_mov_b32 v180, 0
    v_mov_b32 v181, 0
    v_mov_b32 v182, 0
    v_mov_b32 v183, 0
    v_mov_b32 v184, 0
    v_mov_b32 v185, 0
    v_mov_b32 v186, 0
    v_mov_b32 v3, 0
    v_mov_b32 v1, 0
    v_mov_b32 v5, 0
    v_mov_b32 v6, 0
    v_mov_b32 v17, 0
    v_mov_b32 v21, 0
    v_mov_b32 v254, 0
    v_mov_b32 v255, 0
    s_branch concat_heads__sliding_block__grouped_kv_mqa__prompt_kernel_law
concat_heads__sliding_block__grouped_kv_mqa__prompt_kernel_la:
    s_add_u32 m0, s44, s43
    s_nop 0
    buffer_load_dwordx4 v76, s[4:7], s41 offen lds
    s_add_u32 m0, m0, 1024
    s_nop 0
    buffer_load_dwordx4 v77, s[4:7], s41 offen lds
    s_add_u32 m0, m0, 1024
    s_nop 0
    buffer_load_dwordx4 v78, s[4:7], s41 offen lds
    s_add_u32 m0, m0, 1024
    s_nop 0
    buffer_load_dwordx4 v79, s[4:7], s41 offen lds
    s_add_u32 m0, s45, s43
    s_nop 0
concat_heads__sliding_block__grouped_kv_mqa__prompt_kernel_law:
    buffer_load_dwordx4 v80, s[8:11], s42 offen lds
    s_add_u32 m0, m0, 1024
    s_nop 0
    buffer_load_dwordx4 v81, s[8:11], s42 offen lds
    s_add_u32 m0, m0, 1024
    s_nop 0
    buffer_load_dwordx4 v82, s[8:11], s42 offen lds
    s_add_u32 m0, m0, 1024
    s_nop 0
    buffer_load_dwordx4 v83, s[8:11], s42 offen lds
    s_add_u32 m0, m0, 1024
    s_nop 0
    buffer_load_dwordx4 v84, s[8:11], s42 offen lds
    s_add_u32 s41, s41, 128
    s_add_u32 s42, s42, 245760
    s_add_u32 s43, s43, 36864
    s_cmp_eq_u32 s43, 147456
    s_cselect_b32 s43, 0, s43
    s_add_u32 s46, s46, 1
    s_cmp_lt_u32 s46, 4
    s_cbranch_scc1 concat_heads__sliding_block__grouped_kv_mqa__prompt_kernel_lramp
    s_cmp_eq_u32 s46, 99
    s_cbranch_scc1 concat_heads__sliding_block__grouped_kv_mqa__prompt_kernel_lm1
concat_heads__sliding_block__grouped_kv_mqa__prompt_kernel_lmr:
    s_waitcnt vmcnt(18)
    s_barrier
    s_cmp_lt_u32 s46, 10
    s_cbranch_scc1 concat_heads__sliding_block__grouped_kv_mqa__prompt_kernel_la
    buffer_load_dword v85, off, s[32:35], 0 sc1
concat_heads__sliding_block__grouped_kv_mqa__prompt_kernel_lb0:
    s_mov_b32 s41, 0
    s_and_b32 s2, s37, 1
    s_lshl_b32 s2, s2, 2
    s_add_u32 s2, s2, s38
    s_mul_i32 s42, s2, 160
    s_lshl_b32 s44, s40, 11
    s_mul_i32 s45, s40, 3
    s_min_u32 s45, s45, 8
    s_lshl_b32 s45, s45, 10
    s_add_u32 s45, s45, 8192
    s_add_u32 m0, s44, 0
    s_nop 0
    buffer_load_dwordx4 v180, s[12:15], s41 offen lds
    s_add_u32 m0, m0, 1024
    s_nop 0
    buffer_load_dwordx4 v181, s[12:15], s41 offen lds
    s_add_u32 m0, s45, 0
    s_add_u32 s41, s41, 128
    buffer_load_dwordx4 v182, s[16:19], s42 offen lds
    s_add_u32 m0, m0, 1024
    s_cmp_ge_u32 s40, 2
    buffer_load_dwordx4 v183, s[16:19], s42 offen lds
    s_cbranch_scc1 concat_heads__sliding_block__grouped_kv_mqa__prompt_kernel_lib10
    s_add_u32 m0, m0, 1024
    s_nop 0
    buffer_load_dwordx4 v184, s[16:19], s42 offen lds
concat_heads__sliding_block__grouped_kv_mqa__prompt_kernel_lib10:
    s_add_u32 s42, s42, 81920
    s_add_u32 m0, s44, 18432
    s_nop 0
    buffer_load_dwordx4 v180, s[12:15], s41 offen lds
    s_add_u32 m0, m0, 1024
    s_nop 0
    buffer_load_dwordx4 v181, s[12:15], s41 offen lds
    s_add_u32 m0, s45, 18432
    s_add_u32 s41, s41, 128
    buffer_load_dwordx4 v182, s[16:19], s42 offen lds
    s_add_u32 m0, m0, 1024
    s_cmp_ge_u32 s40, 2
    buffer_load_dwordx4 v183, s[16:19], s42 offen lds
    s_cbranch_scc1 concat_heads__sliding_block__grouped_kv_mqa__prompt_kernel_lib11
    s_add_u32 m0, m0, 1024
    s_nop 0
    buffer_load_dwordx4 v184, s[16:19], s42 offen lds
concat_heads__sliding_block__grouped_kv_mqa__prompt_kernel_lib11:
    s_add_u32 s42, s42, 81920
    s_cmp_eq_u32 s38, 3
    s_cbranch_scc1 concat_heads__sliding_block__grouped_kv_mqa__prompt_kernel_lsk8
    s_waitcnt vmcnt(17)
    s_barrier
concat_heads__sliding_block__grouped_kv_mqa__prompt_kernel_lsk8:
    s_add_u32 m0, s44, 36864
    s_nop 0
    buffer_load_dwordx4 v180, s[12:15], s41 offen lds
    s_add_u32 m0, m0, 1024
    s_nop 0
    buffer_load_dwordx4 v181, s[12:15], s41 offen lds
    s_add_u32 m0, s45, 36864
    s_add_u32 s41, s41, 128
    buffer_load_dwordx4 v182, s[16:19], s42 offen lds
    s_add_u32 m0, m0, 1024
    s_cmp_ge_u32 s40, 2
    buffer_load_dwordx4 v183, s[16:19], s42 offen lds
    s_cbranch_scc1 concat_heads__sliding_block__grouped_kv_mqa__prompt_kernel_lib12
    s_add_u32 m0, m0, 1024
    s_nop 0
    buffer_load_dwordx4 v184, s[16:19], s42 offen lds
concat_heads__sliding_block__grouped_kv_mqa__prompt_kernel_lib12:
    s_add_u32 s42, s42, 81920
    s_add_u32 m0, s44, 55296
    s_nop 0
    buffer_load_dwordx4 v180, s[12:15], s41 offen lds
    s_add_u32 m0, m0, 1024
    s_nop 0
    buffer_load_dwordx4 v181, s[12:15], s41 offen lds
    s_add_u32 m0, s45, 55296
    s_add_u32 s41, s41, 128
    buffer_load_dwordx4 v182, s[16:19], s42 offen lds
    s_add_u32 m0, m0, 1024
    s_cmp_ge_u32 s40, 2
    buffer_load_dwordx4 v183, s[16:19], s42 offen lds
    s_cbranch_scc1 concat_heads__sliding_block__grouped_kv_mqa__prompt_kernel_lib13
    s_add_u32 m0, m0, 1024
    s_nop 0
    buffer_load_dwordx4 v184, s[16:19], s42 offen lds
concat_heads__sliding_block__grouped_kv_mqa__prompt_kernel_lib13:
    s_add_u32 s42, s42, 81920
    s_cmp_eq_u32 s38, 3
    s_cbranch_scc1 concat_heads__sliding_block__grouped_kv_mqa__prompt_kernel_lsk9
    s_waitcnt vmcnt(16)
    s_barrier
concat_heads__sliding_block__grouped_kv_mqa__prompt_kernel_lsk9:
    s_add_u32 m0, s44, 73728
    s_nop 0
    buffer_load_dwordx4 v180, s[12:15], s41 offen lds
    s_add_u32 m0, m0, 1024
    s_nop 0
    buffer_load_dwordx4 v181, s[12:15], s41 offen lds
    s_add_u32 m0, s45, 73728
    s_add_u32 s41, s41, 128
    buffer_load_dwordx4 v182, s[16:19], s42 offen lds
    s_add_u32 m0, m0, 1024
    s_cmp_ge_u32 s40, 2
    buffer_load_dwordx4 v183, s[16:19], s42 offen lds
    s_cbranch_scc1 concat_heads__sliding_block__grouped_kv_mqa__prompt_kernel_lib14
    s_add_u32 m0, m0, 1024
    s_nop 0
    buffer_load_dwordx4 v184, s[16:19], s42 offen lds
concat_heads__sliding_block__grouped_kv_mqa__prompt_kernel_lib14:
    s_add_u32 s42, s42, 81920
    s_add_u32 m0, s44, 92160
    s_nop 0
    buffer_load_dwordx4 v180, s[12:15], s41 offen lds
    s_add_u32 m0, m0, 1024
    s_nop 0
    buffer_load_dwordx4 v181, s[12:15], s41 offen lds
    s_add_u32 m0, s45, 92160
    s_add_u32 s41, s41, 128
    buffer_load_dwordx4 v182, s[16:19], s42 offen lds
    s_add_u32 m0, m0, 1024
    s_cmp_ge_u32 s40, 2
    buffer_load_dwordx4 v183, s[16:19], s42 offen lds
    s_cbranch_scc1 concat_heads__sliding_block__grouped_kv_mqa__prompt_kernel_lib15
    s_add_u32 m0, m0, 1024
    s_nop 0
    buffer_load_dwordx4 v184, s[16:19], s42 offen lds
concat_heads__sliding_block__grouped_kv_mqa__prompt_kernel_lib15:
    s_add_u32 s42, s42, 81920
    s_cmp_eq_u32 s38, 3
    s_cbranch_scc1 concat_heads__sliding_block__grouped_kv_mqa__prompt_kernel_lsk10
    s_waitcnt vmcnt(20)
    s_mov_b32 s3, 0
concat_heads__sliding_block__grouped_kv_mqa__prompt_kernel_spdbg:
    v_cmp_gt_u32 vcc, 1, v85
    s_add_u32 s3, s3, 1
    s_cbranch_vccz concat_heads__sliding_block__grouped_kv_mqa__prompt_kernel_sddbg
    s_cmp_gt_u32 s3, 400000
    s_cbranch_scc1 concat_heads__sliding_block__grouped_kv_mqa__prompt_kernel_sddbg
    s_sleep 1
    buffer_load_dword v85, off, s[32:35], 0  sc1
    s_waitcnt vmcnt(0)
    s_branch concat_heads__sliding_block__grouped_kv_mqa__prompt_kernel_spdbg
concat_heads__sliding_block__grouped_kv_mqa__prompt_kernel_sddbg:
    s_barrier
concat_heads__sliding_block__grouped_kv_mqa__prompt_kernel_lsk10:
    buffer_load_dword v85, v185, s[20:23], 0 offen sc1
    s_add_u32 m0, s44, 110592
    s_nop 0
    buffer_load_dwordx4 v180, s[12:15], s41 offen lds
    s_add_u32 m0, m0, 1024
    s_nop 0
    buffer_load_dwordx4 v181, s[12:15], s41 offen lds
    s_add_u32 m0, s45, 110592
    s_add_u32 s41, s41, 128
    buffer_load_dwordx4 v182, s[16:19], s42 offen lds
    s_add_u32 m0, m0, 1024
    s_cmp_ge_u32 s40, 2
    buffer_load_dwordx4 v183, s[16:19], s42 offen lds
    s_cbranch_scc1 concat_heads__sliding_block__grouped_kv_mqa__prompt_kernel_lib16
    s_add_u32 m0, m0, 1024
    s_nop 0
    buffer_load_dwordx4 v184, s[16:19], s42 offen lds
concat_heads__sliding_block__grouped_kv_mqa__prompt_kernel_lib16:
    s_add_u32 s42, s42, 81920
    s_add_u32 m0, s44, 129024
    s_nop 0
    buffer_load_dwordx4 v180, s[12:15], s41 offen lds
    s_add_u32 m0, m0, 1024
    s_nop 0
    buffer_load_dwordx4 v181, s[12:15], s41 offen lds
    s_add_u32 m0, s45, 129024
    s_add_u32 s41, s41, 128
    buffer_load_dwordx4 v182, s[16:19], s42 offen lds
    s_add_u32 m0, m0, 1024
    s_cmp_ge_u32 s40, 2
    buffer_load_dwordx4 v183, s[16:19], s42 offen lds
    s_cbranch_scc1 concat_heads__sliding_block__grouped_kv_mqa__prompt_kernel_lib17
    s_add_u32 m0, m0, 1024
    s_nop 0
    buffer_load_dwordx4 v184, s[16:19], s42 offen lds
concat_heads__sliding_block__grouped_kv_mqa__prompt_kernel_lib17:
    s_add_u32 s42, s42, 81920
    s_cmp_eq_u32 s38, 3
    s_cbranch_scc0 concat_heads__sliding_block__grouped_kv_mqa__prompt_kernel_lb11
    s_waitcnt vmcnt(29)
    s_barrier
concat_heads__sliding_block__grouped_kv_mqa__prompt_kernel_lb11:
    s_waitcnt vmcnt(24)
    s_barrier
    s_waitcnt vmcnt(8)
    s_barrier
    s_mov_b32 s3, 0
concat_heads__sliding_block__grouped_kv_mqa__prompt_kernel_spkvb:
    v_cmp_gt_u32 vcc, 1, v85
    s_add_u32 s3, s3, 1
    s_cbranch_vccz concat_heads__sliding_block__grouped_kv_mqa__prompt_kernel_sdkvb
    s_cmp_gt_u32 s3, 400000
    s_cbranch_scc1 concat_heads__sliding_block__grouped_kv_mqa__prompt_kernel_sdkvb
    buffer_load_dword v85, v185, s[20:23], 0 offen sc1
    s_waitcnt vmcnt(0)
    s_branch concat_heads__sliding_block__grouped_kv_mqa__prompt_kernel_spkvb
concat_heads__sliding_block__grouped_kv_mqa__prompt_kernel_sdkvb:
    s_mul_i32 s2, s40, 6144
    s_add_u32 m0, s2, 0
    s_mov_b32 s2, 5767168
    buffer_load_dwordx4 v186, s[20:23], s2 offen sc1 lds
    buffer_load_dwordx4 v186, s[20:23], s2 offen offset:1024 sc1 lds
    buffer_load_dwordx4 v186, s[20:23], s2 offen offset:2048 sc1 lds
    s_waitcnt vmcnt(11)
    s_barrier
    s_mul_i32 s2, s40, 6144
    s_add_u32 m0, s2, 3072
    s_mov_b32 s2, 5770240
    buffer_load_dwordx4 v186, s[20:23], s2 offen sc1 lds
    s_cmp_eq_u32 s40, 3
    s_cbranch_scc1 concat_heads__sliding_block__grouped_kv_mqa__prompt_kernel_lrg0
    buffer_load_dwordx4 v186, s[20:23], s2 offen offset:1024 sc1 lds
    buffer_load_dwordx4 v186, s[20:23], s2 offen offset:2048 sc1 lds
concat_heads__sliding_block__grouped_kv_mqa__prompt_kernel_lrg0:
    s_waitcnt vmcnt(12)
    s_barrier
    s_add_u32 m0, s44, 55296
    s_nop 0
    buffer_load_dwordx4 v180, s[12:15], s41 offen lds
    s_add_u32 m0, m0, 1024
    s_nop 0
    buffer_load_dwordx4 v181, s[12:15], s41 offen lds
    s_add_u32 m0, s45, 55296
    s_add_u32 s41, s41, 128
    buffer_load_dwordx4 v182, s[16:19], s42 offen lds
    s_add_u32 m0, m0, 1024
    s_cmp_ge_u32 s40, 2
    buffer_load_dwordx4 v183, s[16:19], s42 offen lds
    s_cbranch_scc1 concat_heads__sliding_block__grouped_kv_mqa__prompt_kernel_lib18
    s_add_u32 m0, m0, 1024
    s_nop 0
    buffer_load_dwordx4 v184, s[16:19], s42 offen lds
concat_heads__sliding_block__grouped_kv_mqa__prompt_kernel_lib18:
    s_add_u32 s42, s42, 81920
    s_waitcnt vmcnt(16)
    s_barrier
    s_add_u32 m0, s44, 73728
    s_nop 0
    buffer_load_dwordx4 v180, s[12:15], s41 offen lds
    s_add_u32 m0, m0, 1024
    s_nop 0
    buffer_load_dwordx4 v181, s[12:15], s41 offen lds
    s_add_u32 m0, s45, 73728
    s_add_u32 s41, s41, 128
    buffer_load_dwordx4 v182, s[16:19], s42 offen lds
    s_add_u32 m0, m0, 1024
    s_cmp_ge_u32 s40, 2
    buffer_load_dwordx4 v183, s[16:19], s42 offen lds
    s_cbranch_scc1 concat_heads__sliding_block__grouped_kv_mqa__prompt_kernel_lib19
    s_add_u32 m0, m0, 1024
    s_nop 0
    buffer_load_dwordx4 v184, s[16:19], s42 offen lds
concat_heads__sliding_block__grouped_kv_mqa__prompt_kernel_lib19:
    s_add_u32 s42, s42, 81920
    s_waitcnt vmcnt(16)
    s_barrier
    s_waitcnt vmcnt(12)
    s_barrier
    s_waitcnt vmcnt(4)
    s_barrier
    s_waitcnt vmcnt(0)
    s_barrier
    s_mul_i32 s2, s40, 6144
    s_add_u32 m0, s2, 32768
    s_mov_b32 s2, 5789696
    buffer_load_dwordx4 v186, s[20:23], s2 offen sc1 lds
    buffer_load_dwordx4 v186, s[20:23], s2 offen offset:1024 sc1 lds
    buffer_load_dwordx4 v186, s[20:23], s2 offen offset:2048 sc1 lds
    s_mul_i32 s2, s40, 6144
    s_add_u32 m0, s2, 35840
    s_mov_b32 s2, 5792768
    buffer_load_dwordx4 v186, s[20:23], s2 offen sc1 lds
    s_cmp_eq_u32 s40, 3
    s_cbranch_scc1 concat_heads__sliding_block__grouped_kv_mqa__prompt_kernel_lrg32768
    buffer_load_dwordx4 v186, s[20:23], s2 offen offset:1024 sc1 lds
    buffer_load_dwordx4 v186, s[20:23], s2 offen offset:2048 sc1 lds
concat_heads__sliding_block__grouped_kv_mqa__prompt_kernel_lrg32768:
    s_setprio 0
    v_mov_b32 v7, 163328
    v_mov_b32 v8, 0
    ds_write_b32 v7, v8
    s_barrier
    v_and_b32 v7, 31, v0
    v_lshrrev_b32 v8, 5, v0
    v_lshlrev_b32 v10, 2, v8
    v_sub_u32 v10, v7, v10
    v_mov_b32 v11, 0xf149f2ca
    v_cmp_gt_i32 s[40:41], 0, v10
    v_cmp_gt_i32 s[42:43], 1, v10
    v_cmp_gt_i32 s[44:45], 2, v10
    v_cmp_gt_i32 s[46:47], 3, v10
    v_cndmask_b32 v60, v11, 0, s[40:41]
    v_cndmask_b32 v44, 0, v11, s[40:41]
    v_cndmask_b32 v61, v11, 0, s[42:43]
    v_cndmask_b32 v45, 0, v11, s[42:43]
    v_cndmask_b32 v62, v11, 0, s[44:45]
    v_cndmask_b32 v46, 0, v11, s[44:45]
    v_cndmask_b32 v63, v11, 0, s[46:47]
    v_cndmask_b32 v47, 0, v11, s[46:47]
    v_cmp_gt_i32 s[40:41], 8, v10
    v_cmp_gt_i32 s[42:43], 9, v10
    v_cmp_gt_i32 s[44:45], 10, v10
    v_cmp_gt_i32 s[46:47], 11, v10
    v_cndmask_b32 v64, v11, 0, s[40:41]
    v_cndmask_b32 v48, 0, v11, s[40:41]
    v_cndmask_b32 v65, v11, 0, s[42:43]
    v_cndmask_b32 v49, 0, v11, s[42:43]
    v_cndmask_b32 v66, v11, 0, s[44:45]
    v_cndmask_b32 v50, 0, v11, s[44:45]
    v_cndmask_b32 v67, v11, 0, s[46:47]
    v_cndmask_b32 v51, 0, v11, s[46:47]
    v_cmp_gt_i32 s[40:41], 16, v10
    v_cmp_gt_i32 s[42:43], 17, v10
    v_cmp_gt_i32 s[44:45], 18, v10
    v_cmp_gt_i32 s[46:47], 19, v10
    v_cndmask_b32 v68, v11, 0, s[40:41]
    v_cndmask_b32 v52, 0, v11, s[40:41]
    v_cndmask_b32 v69, v11, 0, s[42:43]
    v_cndmask_b32 v53, 0, v11, s[42:43]
    v_cndmask_b32 v70, v11, 0, s[44:45]
    v_cndmask_b32 v54, 0, v11, s[44:45]
    v_cndmask_b32 v71, v11, 0, s[46:47]
    v_cndmask_b32 v55, 0, v11, s[46:47]
    v_cmp_gt_i32 s[40:41], 24, v10
    v_cmp_gt_i32 s[42:43], 25, v10
    v_cmp_gt_i32 s[44:45], 26, v10
    v_cmp_gt_i32 s[46:47], 27, v10
    v_cndmask_b32 v72, v11, 0, s[40:41]
    v_cndmask_b32 v56, 0, v11, s[40:41]
    v_cndmask_b32 v73, v11, 0, s[42:43]
    v_cndmask_b32 v57, 0, v11, s[42:43]
    v_cndmask_b32 v74, v11, 0, s[44:45]
    v_cndmask_b32 v58, 0, v11, s[44:45]
    v_cndmask_b32 v75, v11, 0, s[46:47]
    v_cndmask_b32 v59, 0, v11, s[46:47]
    s_barrier
    s_waitcnt vmcnt(4) lgkmcnt(0)
    s_branch concat_heads__sliding_block__grouped_kv_mqa__prompt_kernel_x1
concat_heads__sliding_block__grouped_kv_mqa__prompt_kernel_lramp:
    s_cmp_eq_u32 s46, 2
    s_cbranch_scc0 concat_heads__sliding_block__grouped_kv_mqa__prompt_kernel_la
    s_setprio 0
    s_branch concat_heads__sliding_block__grouped_kv_mqa__prompt_kernel_lsb
concat_heads__sliding_block__grouped_kv_mqa__prompt_kernel_lret:
    s_setprio 0
    s_waitcnt vmcnt(9)
    s_barrier
    s_branch concat_heads__sliding_block__grouped_kv_mqa__prompt_kernel_la
concat_heads__sliding_block__grouped_kv_mqa__prompt_kernel_lm1:
    v_and_b32 v7, 31, v0
    v_lshrrev_b32 v8, 5, v0
    v_lshlrev_b32 v10, 2, v8
    v_sub_u32 v10, v7, v10
    v_mov_b32 v11, 0xf149f2ca
    v_cmp_gt_i32 s[0:1], 0, v10
    v_cmp_gt_i32 s[2:3], 1, v10
    s_nop 0
    v_cndmask_b32 v60, v11, 0, s[0:1]
    v_cndmask_b32 v44, 0, v11, s[0:1]
    v_cndmask_b32 v61, v11, 0, s[2:3]
    v_cndmask_b32 v45, 0, v11, s[2:3]
    v_cmp_gt_i32 s[0:1], 2, v10
    v_cmp_gt_i32 s[2:3], 3, v10
    s_nop 0
    v_cndmask_b32 v62, v11, 0, s[0:1]
    v_cndmask_b32 v46, 0, v11, s[0:1]
    v_cndmask_b32 v63, v11, 0, s[2:3]
    v_cndmask_b32 v47, 0, v11, s[2:3]
    v_cmp_gt_i32 s[0:1], 8, v10
    v_cmp_gt_i32 s[2:3], 9, v10
    s_nop 0
    v_cndmask_b32 v64, v11, 0, s[0:1]
    v_cndmask_b32 v48, 0, v11, s[0:1]
    v_cndmask_b32 v65, v11, 0, s[2:3]
    v_cndmask_b32 v49, 0, v11, s[2:3]
    v_cmp_gt_i32 s[0:1], 10, v10
    v_cmp_gt_i32 s[2:3], 11, v10
    s_nop 0
    v_cndmask_b32 v66, v11, 0, s[0:1]
    v_cndmask_b32 v50, 0, v11, s[0:1]
    v_cndmask_b32 v67, v11, 0, s[2:3]
    v_cndmask_b32 v51, 0, v11, s[2:3]
    v_cmp_gt_i32 s[0:1], 16, v10
    v_cmp_gt_i32 s[2:3], 17, v10
    s_nop 0
    v_cndmask_b32 v68, v11, 0, s[0:1]
    v_cndmask_b32 v52, 0, v11, s[0:1]
    v_cndmask_b32 v69, v11, 0, s[2:3]
    v_cndmask_b32 v53, 0, v11, s[2:3]
    v_cmp_gt_i32 s[0:1], 18, v10
    v_cmp_gt_i32 s[2:3], 19, v10
    s_nop 0
    v_cndmask_b32 v70, v11, 0, s[0:1]
    v_cndmask_b32 v54, 0, v11, s[0:1]
    v_cndmask_b32 v71, v11, 0, s[2:3]
    v_cndmask_b32 v55, 0, v11, s[2:3]
    v_cmp_gt_i32 s[0:1], 24, v10
    v_cmp_gt_i32 s[2:3], 25, v10
    s_nop 0
    v_cndmask_b32 v72, v11, 0, s[0:1]
    v_cndmask_b32 v56, 0, v11, s[0:1]
    v_cndmask_b32 v73, v11, 0, s[2:3]
    v_cndmask_b32 v57, 0, v11, s[2:3]
    v_cmp_gt_i32 s[0:1], 26, v10
    v_cmp_gt_i32 s[2:3], 27, v10
    s_nop 0
    v_cndmask_b32 v74, v11, 0, s[0:1]
    v_cndmask_b32 v58, 0, v11, s[0:1]
    v_cndmask_b32 v75, v11, 0, s[2:3]
    v_cndmask_b32 v59, 0, v11, s[2:3]
    s_branch concat_heads__sliding_block__grouped_kv_mqa__prompt_kernel_lmr
concat_heads__sliding_block__grouped_kv_mqa__prompt_kernel_lsb:
    v_lshrrev_b32 v7, 3, v0
    v_lshrrev_b32 v8, 4, v0
    v_xor_b32 v8, v8, v0
    v_and_b32 v8, 7, v8
    v_mul_u32_u24 v7, 1280, v7
    v_lshl_add_u32 v7, v8, 4, v7
    s_lshl_b32 s2, s92, 3
    s_lshr_b32 s3, s37, 5
    s_add_u32 s2, s2, s3
    s_lshl_b32 s2, s2, 2
    s_add_u32 s2, s2, s40
    s_mul_i32 s2, s2, 20480
    v_add_u32 v180, s2, v7
    v_xor_b32 v181, 64, v180
    v_add_u32 v181, 10240, v181
    s_mul_i32 s2, s40, 3
    s_min_u32 s2, s2, 8
    s_lshl_b32 s2, s2, 6
    v_add_u32 v7, s2, v0
    v_mul_u32_u24 v8, 6554, v7
    v_lshrrev_b32 v8, 16, v8
    v_mul_u32_u24 v10, 10, v8
    v_sub_u32 v10, v7, v10
    v_bfe_u32 v11, v8, 2, 1
    v_bfe_u32 v12, v8, 3, 1
    v_and_b32 v8, 0xf3, v8
    v_lshl_or_b32 v8, v11, 3, v8
    v_lshl_or_b32 v8, v12, 2, v8
    v_mul_u32_u24 v8, 1280, v8
    v_lshl_add_u32 v182, v10, 4, v8
    v_add_u32 v7, 64, v7
    v_mul_u32_u24 v8, 6554, v7
    v_lshrrev_b32 v8, 16, v8
    v_mul_u32_u24 v10, 10, v8
    v_sub_u32 v10, v7, v10
    v_bfe_u32 v11, v8, 2, 1
    v_bfe_u32 v12, v8, 3, 1
    v_and_b32 v8, 0xf3, v8
    v_lshl_or_b32 v8, v11, 3, v8
    v_lshl_or_b32 v8, v12, 2, v8
    v_mul_u32_u24 v8, 1280, v8
    v_lshl_add_u32 v183, v10, 4, v8
    v_add_u32 v7, 64, v7
    v_mul_u32_u24 v8, 6554, v7
    v_lshrrev_b32 v8, 16, v8
    v_mul_u32_u24 v10, 10, v8
    v_sub_u32 v10, v7, v10
    v_bfe_u32 v11, v8, 2, 1
    v_bfe_u32 v12, v8, 3, 1
    v_and_b32 v8, 0xf3, v8
    v_lshl_or_b32 v8, v11, 3, v8
    v_lshl_or_b32 v8, v12, 2, v8
    v_mul_u32_u24 v8, 1280, v8
    v_lshl_add_u32 v184, v10, 4, v8
    v_add_u32 v7, 64, v7
    v_lshrrev_b32 v7, 3, v0
    v_and_b32 v8, 7, v0
    v_lshl_add_u32 v7, v7, 5, v8
    v_lshlrev_b32 v7, 7, v7
    v_add_u32 v185, 13818880, v7
    s_mul_i32 s2, s40, 6144
    v_add_u32 v186, s2, v2
    v_mov_b32 v176, 0
    v_mov_b32 v177, 0
    v_mov_b32 v178, 0
    v_mov_b32 v179, 0
    v_mov_b32 v88, 0
    v_mov_b32 v89, 0
    v_mov_b32 v90, 0
    v_mov_b32 v91, 0
    v_mov_b32 v92, 0
    v_mov_b32 v93, 0
    v_mov_b32 v94, 0
    v_mov_b32 v95, 0
    v_mov_b32 v96, 0
    v_mov_b32 v97, 0
    v_mov_b32 v98, 0
    v_mov_b32 v99, 0
    v_mov_b32 v100, 0
    v_mov_b32 v101, 0
    v_mov_b32 v102, 0
    v_mov_b32 v103, 0
    v_mov_b32 v104, 0
    v_mov_b32 v105, 0
    v_mov_b32 v106, 0
    v_mov_b32 v107, 0
    v_mov_b32 v108, 0
    v_mov_b32 v109, 0
    v_mov_b32 v110, 0
    v_mov_b32 v111, 0
    v_mov_b32 v112, 0
    v_mov_b32 v113, 0
    v_mov_b32 v114, 0
    v_mov_b32 v115, 0
    v_mov_b32 v116, 0
    v_mov_b32 v117, 0
    v_mov_b32 v118, 0
    v_mov_b32 v119, 0
    v_mov_b32 v144, 0
    v_mov_b32 v145, 0
    v_mov_b32 v146, 0
    v_mov_b32 v147, 0
    v_mov_b32 v148, 0
    v_mov_b32 v149, 0
    v_mov_b32 v150, 0
    v_mov_b32 v151, 0
    s_branch concat_heads__sliding_block__grouped_kv_mqa__prompt_kernel_const
concat_heads__sliding_block__grouped_kv_mqa__prompt_kernel_t3:
    v_mov_b32 v76, 0
    v_mov_b32 v77, 0
    v_mov_b32 v78, 0
    v_mov_b32 v79, 0
    v_mov_b32 v80, 0
    v_mov_b32 v81, 0
    v_mov_b32 v82, 0
    v_mov_b32 v83, 0
    v_mov_b32 v84, 0
    v_mov_b32 v180, 0
    v_mov_b32 v181, 0
    v_mov_b32 v182, 0
    v_mov_b32 v183, 0
    v_mov_b32 v184, 0
    v_mov_b32 v185, 0
    v_mov_b32 v186, 0
    v_mov_b32 v3, 0
    v_mov_b32 v1, 0
    v_mov_b32 v5, 0
    v_mov_b32 v6, 0
    v_mov_b32 v17, 0
    v_mov_b32 v21, 0
    v_mov_b32 v254, 0
    v_mov_b32 v255, 0
    v_lshrrev_b32 v7, 3, v0
    v_lshrrev_b32 v8, 4, v0
    v_xor_b32 v8, v8, v0
    s_lshl_b32 s2, s36, 2
    v_xor_b32 v8, s2, v8
    v_and_b32 v8, 7, v8
    v_mul_u32_u24 v7, 1280, v7
    v_lshl_add_u32 v7, v8, 4, v7
    s_lshl_b32 s2, s92, 3
    s_lshr_b32 s3, s37, 5
    s_add_u32 s2, s2, s3
    s_lshl_b32 s2, s2, 1
    s_and_b32 s3, s37, 1
    s_add_u32 s39, s2, s3
    s_lshl_b32 s2, s39, 2
    s_and_b32 s3, s36, 3
    s_add_u32 s2, s2, s3
    s_mul_i32 s2, s2, 10240
    s_lshr_b32 s3, s36, 2
    s_lshl_b32 s3, s3, 7
    s_add_u32 s2, s2, s3
    s_mov_b32 s14, 2621440
    s_mov_b32 s15, 0x00020000
    s_mov_b32 s18, 819200
    s_mov_b32 s19, 0x00020000
    s_mov_b32 s22, 13848576
    s_mov_b32 s23, 0x00020000
    s_mov_b32 s26, 819200
    s_mov_b32 s27, 0x00020000
    s_mov_b32 s30, 5242880
    s_mov_b32 s31, 0x00020000
    s_mov_b32 s34, 256
    s_mov_b32 s35, 0x00020000
    s_mov_b32 s7, 0x00020000
    s_mov_b32 s11, 0x00020000
    s_cmp_eq_u32 s38, 3
    s_cselect_b32 s6, 0, 2595840
    s_cselect_b32 s10, 0, 2432000
    s_add_u32 s6, s6, 25600
    s_add_u32 s10, s10, 25600
    s_cmp_eq_u32 s38, 3
    s_waitcnt lgkmcnt(0)
    s_cselect_b32 s4, s50, s40
    s_cselect_b32 s5, s51, s41
    s_cselect_b32 s8, s52, s42
    s_cselect_b32 s9, s53, s43
    s_mov_b64 s[12:13], s[46:47]
    s_mov_b64 s[16:17], s[48:49]
    s_bitcmp1_b32 s37, 0
    s_cselect_b32 s24, s54, s44
    s_cselect_b32 s25, s55, s45
    s_mov_b64 s[28:29], s[56:57]
    s_mov_b64 s[32:33], s[58:59]
    s_cmp_ge_u32 s36, 4
    s_cselect_b32 s44, s42, s40
    s_cselect_b32 s45, s43, s41
    s_mov_b32 s46, 2457600
    s_mov_b32 s47, 0x00020000
    s_cbranch_scc1 concat_heads__sliding_block__grouped_kv_mqa__prompt_kernel_t3w
    v_and_b32 v8, 31, v0
    v_mul_u32_u24 v8, 1280, v8
    v_lshrrev_b32 v10, 5, v0
    v_lshl_add_u32 v8, v10, 7, v8
    s_and_b32 s3, s37, 1
    s_lshl_b32 s3, s3, 2
    s_add_u32 s3, s3, s92
    s_lshl_b32 s3, s3, 3
    s_lshr_b32 s48, s37, 5
    s_add_u32 s3, s3, s48
    s_mul_i32 s3, s39, 40960
    s_lshl_b32 s48, s36, 8
    s_add_u32 s3, s3, s48
    s_add_u32 s3, s3, 256
    s_mov_b32 s46, 2621440
    s_branch concat_heads__sliding_block__grouped_kv_mqa__prompt_kernel_t3x
concat_heads__sliding_block__grouped_kv_mqa__prompt_kernel_t3w:
    v_and_b32 v8, 31, v0
    v_min_u32 v8, 29, v8
    v_lshlrev_b32 v8, 7, v8
    v_lshrrev_b32 v10, 5, v0
    v_mul_u32_u24 v10, 245760, v10
    v_add_u32 v8, v8, v10
    s_sub_u32 s3, s36, 3
    s_lshl_b32 s3, s3, 7
    s_add_u32 s3, s3, s39
    s_mul_i32 s3, s3, 3840
concat_heads__sliding_block__grouped_kv_mqa__prompt_kernel_t3x:
    buffer_load_dword v4, v8, s[44:47], s3 offen
    s_lshl_b32 s3, s36, 10
    s_sub_u32 s40, s36, 4
    s_add_u32 m0, s3, 40960
    s_mov_b32 s48, s3
    buffer_load_dwordx4 v2, s[4:7], s48 offen lds
    s_add_u32 m0, m0, 8192
    s_add_u32 s48, s48, 8192
    buffer_load_dwordx4 v2, s[4:7], s48 offen lds
    s_add_u32 m0, m0, 8192
    s_add_u32 s48, s48, 8192
    buffer_load_dwordx4 v2, s[4:7], s48 offen lds
    s_add_u32 m0, m0, 8192
    s_add_u32 s48, s48, 8192
    s_cmp_eq_u32 s36, 0
    s_cbranch_scc0 concat_heads__sliding_block__grouped_kv_mqa__prompt_kernel_t3s40960
    buffer_load_dwordx4 v2, s[4:7], s48 offen lds
concat_heads__sliding_block__grouped_kv_mqa__prompt_kernel_t3s40960:
    s_add_u32 m0, s3, 73728
    s_mov_b32 s48, s3
    buffer_load_dwordx4 v2, s[8:11], s48 offen lds
    s_add_u32 m0, m0, 8192
    s_add_u32 s48, s48, 8192
    buffer_load_dwordx4 v2, s[8:11], s48 offen lds
    s_add_u32 m0, m0, 8192
    s_add_u32 s48, s48, 8192
    buffer_load_dwordx4 v2, s[8:11], s48 offen lds
    s_add_u32 m0, m0, 8192
    s_add_u32 s48, s48, 8192
    s_cmp_eq_u32 s36, 0
    s_cbranch_scc0 concat_heads__sliding_block__grouped_kv_mqa__prompt_kernel_t3s73728
    buffer_load_dwordx4 v2, s[8:11], s48 offen lds
concat_heads__sliding_block__grouped_kv_mqa__prompt_kernel_t3s73728:
    s_mov_b32 m0, s3
    s_cmp_ge_u32 s36, 4
    s_cbranch_scc1 concat_heads__sliding_block__grouped_kv_mqa__prompt_kernel_t3nw
    s_waitcnt vmcnt(6)
concat_heads__sliding_block__grouped_kv_mqa__prompt_kernel_t3nw:
    buffer_load_dwordx4 v7, s[12:15], s2 offen lds
    s_add_u32 m0, m0, 8192
    s_add_u32 s2, s2, 256
    buffer_load_dwordx4 v7, s[12:15], s2 offen lds
    s_add_u32 m0, m0, 8192
    s_add_u32 s2, s2, 256
    buffer_load_dwordx4 v7, s[12:15], s2 offen lds
    s_add_u32 m0, m0, 8192
    s_add_u32 s2, s2, 256
    buffer_load_dwordx4 v7, s[12:15], s2 offen lds
    s_add_u32 m0, m0, 8192
    s_add_u32 s2, s2, 256
    buffer_load_dwordx4 v7, s[12:15], s2 offen lds
    s_add_u32 m0, m0, 8192
    s_add_u32 s2, s2, 256
    v_lshlrev_b32 v7, 7, v0
    s_cmp_ge_u32 s36, 4
    s_cbranch_scc1 concat_heads__sliding_block__grouped_kv_mqa__prompt_kernel_t3q
    s_lshr_b32 s2, s39, 1
    s_mul_i32 s2, s2, 25600
    s_mul_i32 s3, s36, 6400
    s_add_u32 s2, s2, s3
    buffer_load_dword v4, v7, s[24:27], s2 offen
    s_branch concat_heads__sliding_block__grouped_kv_mqa__prompt_kernel_t3r
concat_heads__sliding_block__grouped_kv_mqa__prompt_kernel_t3q:
    s_mul_i32 s2, s39, 12800
    s_and_b32 s3, s36, 1
    s_mul_i32 s3, s3, 6400
    s_add_u32 s2, s2, s3
    buffer_load_dword v4, v7, s[16:19], s2 offen
concat_heads__sliding_block__grouped_kv_mqa__prompt_kernel_t3r:
    s_cmp_ge_u32 s36, 4
    s_cbranch_scc0 concat_heads__sliding_block__grouped_kv_mqa__prompt_kernel_csetup3
    s_waitcnt vmcnt(1)
    s_barrier
    s_branch concat_heads__sliding_block__grouped_kv_mqa__prompt_kernel_lsb
concat_heads__sliding_block__grouped_kv_mqa__prompt_kernel_csetup:
    v_mov_b32 v76, 0
    v_mov_b32 v77, 0
    v_mov_b32 v78, 0
    v_mov_b32 v79, 0
    v_mov_b32 v80, 0
    v_mov_b32 v81, 0
    v_mov_b32 v82, 0
    v_mov_b32 v83, 0
    v_mov_b32 v84, 0
    v_mov_b32 v180, 0
    v_mov_b32 v181, 0
    v_mov_b32 v182, 0
    v_mov_b32 v183, 0
    v_mov_b32 v184, 0
    v_mov_b32 v185, 0
    v_mov_b32 v186, 0
    v_mov_b32 v3, 0
    v_mov_b32 v1, 0
    v_mov_b32 v5, 0
    v_mov_b32 v6, 0
    v_mov_b32 v17, 0
    v_mov_b32 v21, 0
    v_mov_b32 v254, 0
    v_mov_b32 v255, 0
    s_cmp_eq_u32 s38, 0
    s_cselect_b32 s3, s36, 99
    s_cmp_lt_u32 s3, 4
    s_cbranch_scc0 concat_heads__sliding_block__grouped_kv_mqa__prompt_kernel_ncp
    s_getpc_b64 s[2:3]
concat_heads__sliding_block__grouped_kv_mqa__prompt_kernel_pc:
    s_lshl_b32 s94, s36, 13
    v_lshl_add_u32 v7, v0, 7, s94
    v_min_u32 v7, concat_heads__sliding_block__grouped_kv_mqa__prompt_kernel_last-concat_heads__sliding_block__grouped_kv_mqa__prompt_kernel_pc, v7
    v_mov_b32 v11, s3
    v_add_co_u32 v10, vcc, s2, v7
    s_nop 1
    v_addc_co_u32 v11, vcc, 0, v11, vcc
    global_load_dword v4, v[10:11], off
concat_heads__sliding_block__grouped_kv_mqa__prompt_kernel_ncp:
    s_mov_b32 s14, 2621440
    s_mov_b32 s15, 0x00020000
    s_mov_b32 s18, 819200
    s_mov_b32 s19, 0x00020000
    s_mov_b32 s22, 13848576
    s_mov_b32 s23, 0x00020000
    s_mov_b32 s26, 819200
    s_mov_b32 s27, 0x00020000
    s_mov_b32 s30, 5242880
    s_mov_b32 s31, 0x00020000
    s_mov_b32 s34, 256
    s_mov_b32 s35, 0x00020000
    s_mov_b32 s7, 0x00020000
    s_mov_b32 s11, 0x00020000
    s_cmp_eq_u32 s38, 3
    s_cselect_b32 s6, 0, 2595840
    s_cselect_b32 s10, 0, 2432000
    s_add_u32 s6, s6, 25600
    s_add_u32 s10, s10, 25600
    s_cmp_eq_u32 s38, 3
    s_waitcnt lgkmcnt(0)
    s_cselect_b32 s4, s50, s40
    s_cselect_b32 s5, s51, s41
    s_cselect_b32 s8, s52, s42
    s_cselect_b32 s9, s53, s43
    s_mov_b64 s[12:13], s[46:47]
    s_mov_b64 s[16:17], s[48:49]
    s_bitcmp1_b32 s37, 0
    s_cselect_b32 s24, s54, s44
    s_cselect_b32 s25, s55, s45
    s_mov_b64 s[28:29], s[56:57]
    s_mov_b64 s[32:33], s[58:59]
    s_cmp_eq_u32 s37, 0
    s_cbranch_scc0 concat_heads__sliding_block__grouped_kv_mqa__prompt_kernel_csetup3
    s_cmp_eq_u32 s36, 0
    s_cbranch_scc0 concat_heads__sliding_block__grouped_kv_mqa__prompt_kernel_csetup3
    v_lshlrev_b32 v7, 7, v0
    v_mov_b32 v8, 0
    s_mov_b32 s3, 13815808
    buffer_store_dword v8, v7, s[20:23], s3 offen sc1
    s_add_u32 s3, s3, 8192
    buffer_store_dword v8, v7, s[20:23], s3 offen sc1
    s_add_u32 s3, s3, 8192
    buffer_store_dword v8, v7, s[20:23], s3 offen sc1
    s_add_u32 s3, s3, 8192
    buffer_store_dword v8, v7, s[20:23], s3 offen sc1
    v_mov_b32 v8, 1
    s_waitcnt vmcnt(0)
    s_mov_b64 exec, 1
    buffer_store_dword v8, off, s[32:35], 0 sc1
    s_mov_b64 exec, -1
concat_heads__sliding_block__grouped_kv_mqa__prompt_kernel_csetup3:
    v_and_b32 v7, 15, v0
    v_lshrrev_b32 v8, 4, v0
    v_bfe_u32 v10, v0, 1, 3
    v_xor_b32 v10, v10, v8
    v_lshlrev_b32 v10, 4, v10
    v_lshl_add_u32 v10, v7, 7, v10
    s_lshr_b32 s3, s36, 1
    s_lshl_b32 s3, s3, 13
    s_add_u32 s3, s3, 73728
    v_add_u32 v76, s3, v10
    v_xor_b32 v77, 64, v76
    s_and_b32 s3, s36, 1
    s_lshl_b32 s3, s3, 12
    s_lshl_b32 s2, s36, 5
    s_and_b32 s2, s2, 64
    v_xor_b32 v83, s2, v10
    v_add_u32 v83, s3, v83
    v_bfe_u32 v10, v0, 2, 2
    v_and_b32 v11, 3, v0
    v_bfe_u32 v12, v0, 4, 1
    v_lshl_add_u32 v7, v12, 2, v10
    v_lshrrev_b32 v13, 5, v0
    v_lshl_add_u32 v7, v13, 4, v7
    v_mul_u32_u24 v7, 160, v7
    v_mul_u32_u24 v13, 40, v11
    v_add_u32 v7, v7, v13
    s_lshr_b32 s2, s36, 1
    s_mul_i32 s2, s2, 5120
    s_add_u32 s2, s2, 8192
    v_add_u32 v84, s2, v7
    v_lshl_add_u32 v10, v8, 3, v10
    v_mul_u32_u24 v10, 320, v10
    v_add_u32 v10, 90112, v10
    s_cmp_eq_u32 s38, 2
    s_cselect_b32 s2, 8, 40
    s_cselect_b32 s40, 40, 8
    s_and_b32 s3, s36, 1
    s_mul_i32 s3, s3, 160
    v_lshl_add_u32 v12, v12, 5, s3
    v_add3_u32 v13, v13, v12, 32
    v_mul_u32_u24 v11, s2, v11
    v_add_u32 v11, v12, v11
    v_subrev_u32 v12, 320, v11
    v_min_u32 v12, v12, v11
    v_add_u32 v78, v12, v10
    v_add_u32 v11, s40, v11
    v_subrev_u32 v12, 320, v11
    v_min_u32 v12, v12, v11
    v_add_u32 v79, v12, v10
    v_add_u32 v11, s40, v11
    v_subrev_u32 v12, 320, v11
    v_min_u32 v12, v12, v11
    v_add_u32 v80, v12, v10
    v_add_u32 v11, s40, v11
    v_subrev_u32 v12, 320, v11
    v_min_u32 v12, v12, v11
    v_add_u32 v81, v12, v10
    v_subrev_u32 v12, 320, v13
    v_min_u32 v12, v12, v13
    v_add_u32 v82, v12, v10
concat_heads__sliding_block__grouped_kv_mqa__prompt_kernel_const:
    s_mov_b32 s60, 0
    s_mov_b32 s61, -1
    s_mov_b32 s62, 0xfffff
    s_mov_b32 s63, 0xfffff
    s_bfe_u32 s95, s37, 0x30003
    s_and_b32 s2, s37, 7
    s_lshl_b32 s2, s2, 2
    s_lshr_b32 s3, s37, 6
    s_add_u32 s96, s2, s3
    s_lshl_b32 s97, s95, 3
    s_add_u32 s97, s97, s36
    s_lshr_b32 s100, s36, 2
    s_lshl_b32 s2, s92, 3
    s_lshr_b32 s3, s37, 5
    s_add_u32 s2, s2, s3
    s_lshl_b32 s2, s2, 1
    s_add_u32 s99, s2, s100
    s_and_b32 s2, s37, 1
    s_lshl_b32 s2, s2, 2
    s_add_u32 s2, s2, s38
    s_lshl_b32 s2, s2, 2
    s_and_b32 s3, s36, 3
    s_add_u32 s98, s2, s3
    s_mov_b32 s101, 0
    v_mov_b32 v1, 0xdddddddd
    s_cmp_ge_u32 s36, 4
    s_cbranch_scc1 concat_heads__sliding_block__grouped_kv_mqa__prompt_kernel_const2
    v_and_b32 v7, 31, v0
    v_lshrrev_b32 v8, 5, v0
    v_lshlrev_b32 v10, 2, v8
    v_sub_u32 v10, v7, v10
    v_mov_b32 v11, 0xf149f2ca
    v_cmp_gt_i32 s[48:49], 0, v10
    v_cmp_gt_i32 s[50:51], 1, v10
    v_cmp_gt_i32 s[52:53], 2, v10
    v_cmp_gt_i32 s[54:55], 3, v10
    v_cndmask_b32 v60, v11, 0, s[48:49]
    v_cndmask_b32 v44, 0, v11, s[48:49]
    v_cndmask_b32 v61, v11, 0, s[50:51]
    v_cndmask_b32 v45, 0, v11, s[50:51]
    v_cndmask_b32 v62, v11, 0, s[52:53]
    v_cndmask_b32 v46, 0, v11, s[52:53]
    v_cndmask_b32 v63, v11, 0, s[54:55]
    v_cndmask_b32 v47, 0, v11, s[54:55]
    v_cmp_gt_i32 s[48:49], 8, v10
    v_cmp_gt_i32 s[50:51], 9, v10
    v_cmp_gt_i32 s[52:53], 10, v10
    v_cmp_gt_i32 s[54:55], 11, v10
    v_cndmask_b32 v64, v11, 0, s[48:49]
    v_cndmask_b32 v48, 0, v11, s[48:49]
    v_cndmask_b32 v65, v11, 0, s[50:51]
    v_cndmask_b32 v49, 0, v11, s[50:51]
    v_cndmask_b32 v66, v11, 0, s[52:53]
    v_cndmask_b32 v50, 0, v11, s[52:53]
    v_cndmask_b32 v67, v11, 0, s[54:55]
    v_cndmask_b32 v51, 0, v11, s[54:55]
    v_cmp_gt_i32 s[48:49], 16, v10
    v_cmp_gt_i32 s[50:51], 17, v10
    v_cmp_gt_i32 s[52:53], 18, v10
    v_cmp_gt_i32 s[54:55], 19, v10
    v_cndmask_b32 v68, v11, 0, s[48:49]
    v_cndmask_b32 v52, 0, v11, s[48:49]
    v_cndmask_b32 v69, v11, 0, s[50:51]
    v_cndmask_b32 v53, 0, v11, s[50:51]
    v_cndmask_b32 v70, v11, 0, s[52:53]
    v_cndmask_b32 v54, 0, v11, s[52:53]
    v_cndmask_b32 v71, v11, 0, s[54:55]
    v_cndmask_b32 v55, 0, v11, s[54:55]
    v_cmp_gt_i32 s[48:49], 24, v10
    v_cmp_gt_i32 s[50:51], 25, v10
    v_cmp_gt_i32 s[52:53], 26, v10
    v_cmp_gt_i32 s[54:55], 27, v10
    v_cndmask_b32 v72, v11, 0, s[48:49]
    v_cndmask_b32 v56, 0, v11, s[48:49]
    v_cndmask_b32 v73, v11, 0, s[50:51]
    v_cndmask_b32 v57, 0, v11, s[50:51]
    v_cndmask_b32 v74, v11, 0, s[52:53]
    v_cndmask_b32 v58, 0, v11, s[52:53]
    v_cndmask_b32 v75, v11, 0, s[54:55]
    v_cndmask_b32 v59, 0, v11, s[54:55]
concat_heads__sliding_block__grouped_kv_mqa__prompt_kernel_const2:
    v_and_b32 v7, 31, v0
    v_lshrrev_b32 v8, 5, v0
    s_and_b32 s3, s36, 3
    v_lshlrev_b32 v15, 3, v7
    v_mul_u32_u24 v16, 384, v8
    v_cmp_lt_u32 vcc, 27, v7
    v_sub_u32 v10, 384, v16
    s_mov_b64 s[0:1], vcc
    v_min_u32 v11, 23, v7
    v_cndmask_b32 v16, v16, v10, s[0:1]
    v_lshl_add_u32 v16, v11, 4, v16
    s_mul_i32 s2, s36, 2816
    s_add_u32 s2, s2, 58368
    v_add_u32 v18, s2, v2
    v_add_u32 v19, s2, v15
    s_add_u32 s2, s2, 1280
    v_add_u32 v20, s2, v16
    s_mul_i32 s57, s3, 6144
    v_add_u32 v17, s57, v2
    s_mul_i32 s2, s3, 2560
    s_add_u32 s2, s2, 147456
    v_add_u32 v22, s2, v2
    v_add_u32 v23, s2, v15
    s_mul_i32 s2, s100, 11264
    v_add_u32 v14, s2, v2
    s_add_u32 s3, s2, 1024
    v_add_u32 v15, s3, v15
    s_add_u32 s3, s2, 1280
    v_add_u32 v16, s3, v16
    v_mul_u32_u24 v10, 6554, v0
    v_lshrrev_b32 v10, 16, v10
    v_mul_u32_u24 v10, 1120, v10
    v_add_u32 v3, v10, v2
    v_and_b32 v7, 15, v0
    v_bfe_u32 v10, v0, 4, 1
    v_mul_u32_u24 v10, 20480, v10
    v_lshl_add_u32 v7, v7, 4, v10
    v_lshl_add_u32 v5, v8, 8, v7
    v_and_b32 v7, 15, v0
    v_lshl_add_u32 v10, v7, 3, v10
    v_lshl_add_u32 v6, v8, 28, v10
    s_cmp_ge_u32 s36, 4
    s_cbranch_scc1 concat_heads__sliding_block__grouped_kv_mqa__prompt_kernel_cpd
    v_lshrrev_b32 v8, 4, v0
    v_lshlrev_b32 v7, 3, v7
    v_lshl_add_u32 v255, v8, 8, v7
    v_bfe_u32 v11, v0, 2, 2
    v_mul_u32_u24 v253, 40, v8
    v_add3_u32 v253, v253, v11, 16
    v_lshrrev_b32 v252, 1, v8
    v_mul_u32_u24 v252, 20, v252
    v_and_b32 v8, 1, v8
    v_lshl_add_u32 v252, v8, 2, v252
    v_add_u32 v252, v252, v11
    v_mul_u32_u24 v252, 160, v252
    v_mul_u32_u24 v253, 160, v253
    v_and_b32 v8, 3, v0
    v_lshlrev_b32 v8, 3, v8
    v_add_u32 v8, 107520, v8
    v_add_u32 v252, v252, v8
    v_add_u32 v253, v253, v8
    s_lshr_b32 s2, s37, 6
    s_bitcmp1_b32 s37, 0
    s_cbranch_scc1 concat_heads__sliding_block__grouped_kv_mqa__prompt_kernel_cpb
    v_and_b32 v8, 7, v0
    v_bfe_u32 v11, v0, 3, 2
    v_lshl_add_u32 v8, v11, 6, v8
    s_lshl_b32 s3, s92, 2
    s_add_u32 s2, s2, s3
    s_lshr_b32 s2, s2, 1
    s_lshl_b32 s2, s2, 3
    s_branch concat_heads__sliding_block__grouped_kv_mqa__prompt_kernel_cpc
concat_heads__sliding_block__grouped_kv_mqa__prompt_kernel_cpb:
    v_and_b32 v8, 1, v0
    v_bfe_u32 v11, v0, 1, 3
    v_lshl_add_u32 v8, v11, 3, v8
    s_lshl_b32 s2, s2, 6
    s_lshl_b32 s3, s92, 1
    s_add_u32 s2, s2, s3
concat_heads__sliding_block__grouped_kv_mqa__prompt_kernel_cpc:
    v_add_u32 v8, s2, v8
    v_lshlrev_b32 v8, 7, v8
    v_add_u32 v254, 13815808, v8
concat_heads__sliding_block__grouped_kv_mqa__prompt_kernel_cpd:
    v_and_b32 v8, 3, v0
    s_lshl_b32 s2, s95, 1
    s_sub_u32 s2, s2, 2
    v_add_u32 v8, s2, v8
    v_max_i32 v8, 0, v8
    v_lshrrev_b32 v10, 3, v8
    v_and_b32 v8, 7, v8
    v_lshl_add_u32 v8, v8, 5, v10
    v_bfe_u32 v10, v0, 2, 2
    v_min_u32 v10, 2, v10
    v_lshl_add_u32 v8, v10, 3, v8
    s_lshr_b32 s2, s96, 3
    s_lshl_b32 s2, s2, 1
    v_add_u32 v8, s2, v8
    v_lshlrev_b32 v8, 7, v8
    v_add_u32 v21, 13815808, v8
    s_lshl_b32 s2, s96, 6
    s_lshl_b32 s3, s95, 3
    s_add_u32 s2, s2, s3
    s_sub_u32 s2, s2, 8
    s_mul_i32 s58, s2, 2816
    s_cmp_eq_u32 s95, 0
    s_cselect_b32 s59, 22, 44
    s_mov_b32 s56, 22528
    s_mul_i32 s50, s36, 800
    s_add_u32 s50, s50, 107520
    s_mul_i32 s51, s36, 6400
    s_mul_i32 s2, s95, 160
    s_add_u32 s51, s51, s2
    s_mov_b32 s48, -1
    s_mov_b32 s49, 0x3ffff
    s_mul_i32 s2, s97, 40960
    s_add_u32 s2, s2, 8572928
    s_lshl_b32 s52, s96, 9
    s_add_u32 s52, s52, s2
    s_lshl_b32 s3, s96, 7
    s_add_u32 s2, s2, s3
    s_add_u32 s53, s2, 16384
    s_mul_i32 s2, s99, 40960
    s_add_u32 s2, s2, 11194368
    s_lshl_b32 s54, s98, 9
    s_add_u32 s54, s54, s2
    s_lshl_b32 s3, s98, 7
    s_add_u32 s2, s2, s3
    s_add_u32 s55, s2, 16384
    v_mov_b32 v34, 0
    v_mov_b32 v35, 0
    v_mov_b32 v40, 0
    v_mov_b32 v41, 0
    v_mov_b32 v28, 0
    v_mov_b32 v29, 0x3f800000
    s_cmp_eq_u32 s38, 3
    s_cbranch_scc1 concat_heads__sliding_block__grouped_kv_mqa__prompt_kernel_t3go
    s_cmp_ge_u32 s36, 4
    s_cbranch_scc1 concat_heads__sliding_block__grouped_kv_mqa__prompt_kernel_lret
concat_heads__sliding_block__grouped_kv_mqa__prompt_kernel_cgo:
    s_setprio 0
    s_lshr_b32 s40, s36, 1
    s_and_b32 s41, s36, 1
    v_mov_b32 v88, 0
    v_mov_b32 v89, 0
    v_mov_b32 v90, 0
    v_mov_b32 v91, 0
    v_mov_b32 v92, 0
    v_mov_b32 v93, 0
    v_mov_b32 v94, 0
    v_mov_b32 v95, 0
    v_mov_b32 v96, 0
    v_mov_b32 v97, 0
    v_mov_b32 v98, 0
    v_mov_b32 v99, 0
    v_mov_b32 v100, 0
    v_mov_b32 v101, 0
    v_mov_b32 v102, 0
    v_mov_b32 v103, 0
    v_mov_b32 v104, 0
    v_mov_b32 v105, 0
    v_mov_b32 v106, 0
    v_mov_b32 v107, 0
    v_mov_b32 v108, 0
    v_mov_b32 v109, 0
    v_mov_b32 v110, 0
    v_mov_b32 v111, 0
    v_mov_b32 v112, 0
    v_mov_b32 v113, 0
    v_mov_b32 v114, 0
    v_mov_b32 v115, 0
    v_mov_b32 v116, 0
    v_mov_b32 v117, 0
    v_mov_b32 v118, 0
    v_mov_b32 v119, 0
    v_mov_b32 v120, 0
    v_mov_b32 v121, 0
    v_mov_b32 v122, 0
    v_mov_b32 v123, 0
    v_mov_b32 v124, 0
    v_mov_b32 v125, 0
    v_mov_b32 v126, 0
    v_mov_b32 v127, 0
    v_mov_b32 v128, 0
    v_mov_b32 v129, 0
    v_mov_b32 v130, 0
    v_mov_b32 v131, 0
    v_mov_b32 v132, 0
    v_mov_b32 v133, 0
    v_mov_b32 v134, 0
    v_mov_b32 v135, 0
    v_mov_b32 v136, 0
    v_mov_b32 v137, 0
    v_mov_b32 v138, 0
    v_mov_b32 v139, 0
    v_mov_b32 v140, 0
    v_mov_b32 v141, 0
    v_mov_b32 v142, 0
    v_mov_b32 v143, 0
    v_mov_b32 v144, 0
    v_mov_b32 v145, 0
    v_mov_b32 v146, 0
    v_mov_b32 v147, 0
    v_mov_b32 v148, 0
    v_mov_b32 v149, 0
    v_mov_b32 v150, 0
    v_mov_b32 v151, 0
    v_mov_b32 v152, 0
    v_mov_b32 v153, 0
    v_mov_b32 v154, 0
    v_mov_b32 v155, 0
    v_mov_b32 v156, 0
    v_mov_b32 v157, 0
    v_mov_b32 v158, 0
    v_mov_b32 v159, 0
    v_mov_b32 v160, 0
    v_mov_b32 v161, 0
    v_mov_b32 v162, 0
    v_mov_b32 v163, 0
    v_mov_b32 v164, 0
    v_mov_b32 v165, 0
    v_mov_b32 v166, 0
    v_mov_b32 v167, 0
    s_mov_b32 s43, 2
    s_mov_b32 s94, 10
    s_barrier
    s_cmp_eq_u32 s38, 2
    s_cbranch_scc0 concat_heads__sliding_block__grouped_kv_mqa__prompt_kernel_c_qk
concat_heads__sliding_block__grouped_kv_mqa__prompt_kernel_c_v:
    ds_read_b128 v[180:183], v76 offset:0
    ds_read_b64_tr_b16 v[212:213], v78 offset:0
    ds_read_b64_tr_b16 v[214:215], v78 offset:1280
    ds_read_b64_tr_b16 v[216:217], v79 offset:0
    ds_read_b64_tr_b16 v[218:219], v79 offset:1280
    ds_read_b128 v[184:187], v76 offset:2048
    ds_read_b64_tr_b16 v[220:221], v80 offset:0
    ds_read_b64_tr_b16 v[222:223], v80 offset:1280
    ds_read_b64_tr_b16 v[224:225], v81 offset:0
    ds_read_b64_tr_b16 v[226:227], v81 offset:1280
    ds_read_b64_tr_b16 v[228:229], v82 offset:0
    ds_read_b64_tr_b16 v[230:231], v82 offset:1280
    ds_read_b128 v[188:191], v76 offset:4096
    ds_read_b128 v[192:195], v76 offset:6144
.p2align 6
concat_heads__sliding_block__grouped_kv_mqa__prompt_kernel_c_v_loop:
    s_waitcnt lgkmcnt(0)
    v_mfma_f32_16x16x32_bf16 v[88:91], v[180:183], v[212:215], v[88:91]
    ds_read_b128 v[196:199], v77 offset:0
    ds_read_b64_tr_b16 v[232:233], v78 offset:10240
    v_mfma_f32_16x16x32_bf16 v[92:95], v[180:183], v[216:219], v[92:95]
    ds_read_b64_tr_b16 v[234:235], v78 offset:11520
    ds_read_b64_tr_b16 v[236:237], v79 offset:10240
    v_mfma_f32_16x16x32_bf16 v[96:99], v[180:183], v[220:223], v[96:99]
    ds_read_b64_tr_b16 v[238:239], v79 offset:11520
    ds_read_b128 v[200:203], v77 offset:2048
    v_mfma_f32_16x16x32_bf16 v[100:103], v[180:183], v[224:227], v[100:103]
    ds_read_b64_tr_b16 v[240:241], v80 offset:10240
    ds_read_b64_tr_b16 v[242:243], v80 offset:11520
    v_mfma_f32_16x16x32_bf16 v[104:107], v[180:183], v[228:231], v[104:107]
    ds_read_b64_tr_b16 v[244:245], v81 offset:10240
    ds_read_b64_tr_b16 v[246:247], v81 offset:11520
    v_mfma_f32_16x16x32_bf16 v[108:111], v[184:187], v[212:215], v[108:111]
    ds_read_b64_tr_b16 v[248:249], v82 offset:10240
    ds_read_b64_tr_b16 v[250:251], v82 offset:11520
    v_mfma_f32_16x16x32_bf16 v[112:115], v[184:187], v[216:219], v[112:115]
    ds_read_b128 v[204:207], v77 offset:4096
    ds_read_b128 v[208:211], v77 offset:6144
    v_mfma_f32_16x16x32_bf16 v[116:119], v[184:187], v[220:223], v[116:119]
    s_add_u32 s43, s43, 1
    s_and_b32 s43, s43, 3
    v_mfma_f32_16x16x32_bf16 v[120:123], v[184:187], v[224:227], v[120:123]
    s_cselect_b32 s42, 0, 4294819840
    s_add_u32 s42, s42, 36864
    v_mfma_f32_16x16x32_bf16 v[124:127], v[184:187], v[228:231], v[124:127]
    v_add_u32 v76, s42, v76
    v_mfma_f32_16x16x32_bf16 v[128:131], v[188:191], v[212:215], v[128:131]
    v_add_u32 v77, s42, v77
    v_mfma_f32_16x16x32_bf16 v[132:135], v[188:191], v[216:219], v[132:135]
    v_add_u32 v78, s42, v78
    v_mfma_f32_16x16x32_bf16 v[136:139], v[188:191], v[220:223], v[136:139]
    v_add_u32 v79, s42, v79
    v_mfma_f32_16x16x32_bf16 v[140:143], v[188:191], v[224:227], v[140:143]
    v_add_u32 v80, s42, v80
    v_mfma_f32_16x16x32_bf16 v[144:147], v[188:191], v[228:231], v[144:147]
    v_add_u32 v81, s42, v81
    v_mfma_f32_16x16x32_bf16 v[148:151], v[192:195], v[212:215], v[148:151]
    v_add_u32 v82, s42, v82
    v_mfma_f32_16x16x32_bf16 v[152:155], v[192:195], v[216:219], v[152:155]
    v_mfma_f32_16x16x32_bf16 v[156:159], v[192:195], v[220:223], v[156:159]
    v_mfma_f32_16x16x32_bf16 v[160:163], v[192:195], v[224:227], v[160:163]
    v_mfma_f32_16x16x32_bf16 v[164:167], v[192:195], v[228:231], v[164:167]
    s_waitcnt lgkmcnt(0)
    s_barrier
    v_mfma_f32_16x16x32_bf16 v[88:91], v[196:199], v[232:235], v[88:91]
    ds_read_b128 v[180:183], v76 offset:0
    ds_read_b64_tr_b16 v[212:213], v78 offset:0
    v_mfma_f32_16x16x32_bf16 v[92:95], v[196:199], v[236:239], v[92:95]
    ds_read_b64_tr_b16 v[214:215], v78 offset:1280
    ds_read_b64_tr_b16 v[216:217], v79 offset:0
    v_mfma_f32_16x16x32_bf16 v[96:99], v[196:199], v[240:243], v[96:99]
    ds_read_b64_tr_b16 v[218:219], v79 offset:1280
    ds_read_b128 v[184:187], v76 offset:2048
    v_mfma_f32_16x16x32_bf16 v[100:103], v[196:199], v[244:247], v[100:103]
    ds_read_b64_tr_b16 v[220:221], v80 offset:0
    ds_read_b64_tr_b16 v[222:223], v80 offset:1280
    v_mfma_f32_16x16x32_bf16 v[104:107], v[196:199], v[248:251], v[104:107]
    ds_read_b64_tr_b16 v[224:225], v81 offset:0
    ds_read_b64_tr_b16 v[226:227], v81 offset:1280
    v_mfma_f32_16x16x32_bf16 v[108:111], v[200:203], v[232:235], v[108:111]
    ds_read_b64_tr_b16 v[228:229], v82 offset:0
    ds_read_b64_tr_b16 v[230:231], v82 offset:1280
    v_mfma_f32_16x16x32_bf16 v[112:115], v[200:203], v[236:239], v[112:115]
    ds_read_b128 v[188:191], v76 offset:4096
    ds_read_b128 v[192:195], v76 offset:6144
    v_mfma_f32_16x16x32_bf16 v[116:119], v[200:203], v[240:243], v[116:119]
    v_mfma_f32_16x16x32_bf16 v[120:123], v[200:203], v[244:247], v[120:123]
    v_mfma_f32_16x16x32_bf16 v[124:127], v[200:203], v[248:251], v[124:127]
    v_mfma_f32_16x16x32_bf16 v[128:131], v[204:207], v[232:235], v[128:131]
    v_mfma_f32_16x16x32_bf16 v[132:135], v[204:207], v[236:239], v[132:135]
    v_mfma_f32_16x16x32_bf16 v[136:139], v[204:207], v[240:243], v[136:139]
    v_mfma_f32_16x16x32_bf16 v[140:143], v[204:207], v[244:247], v[140:143]
    v_mfma_f32_16x16x32_bf16 v[144:147], v[204:207], v[248:251], v[144:147]
    v_mfma_f32_16x16x32_bf16 v[148:151], v[208:211], v[232:235], v[148:151]
    v_mfma_f32_16x16x32_bf16 v[152:155], v[208:211], v[236:239], v[152:155]
    v_mfma_f32_16x16x32_bf16 v[156:159], v[208:211], v[240:243], v[156:159]
    v_mfma_f32_16x16x32_bf16 v[160:163], v[208:211], v[244:247], v[160:163]
    v_mfma_f32_16x16x32_bf16 v[164:167], v[208:211], v[248:251], v[164:167]
    s_sub_u32 s94, s94, 1
    s_cmp_lg_u32 s94, 0
    s_cbranch_scc1 concat_heads__sliding_block__grouped_kv_mqa__prompt_kernel_c_v_loop
    s_waitcnt lgkmcnt(0)
    s_nop 3
    v_cvt_pk_bf16_f32 v180, v88, v89
    v_cvt_pk_bf16_f32 v181, v90, v91
    v_cvt_pk_bf16_f32 v182, v108, v109
    v_cvt_pk_bf16_f32 v183, v110, v111
    v_cvt_pk_bf16_f32 v184, v128, v129
    v_cvt_pk_bf16_f32 v185, v130, v131
    v_cvt_pk_bf16_f32 v186, v148, v149
    v_cvt_pk_bf16_f32 v187, v150, v151
    v_cvt_pk_bf16_f32 v188, v92, v93
    v_cvt_pk_bf16_f32 v189, v94, v95
    v_cvt_pk_bf16_f32 v190, v112, v113
    v_cvt_pk_bf16_f32 v191, v114, v115
    v_cvt_pk_bf16_f32 v192, v132, v133
    v_cvt_pk_bf16_f32 v193, v134, v135
    v_cvt_pk_bf16_f32 v194, v152, v153
    v_cvt_pk_bf16_f32 v195, v154, v155
    v_cvt_pk_bf16_f32 v196, v96, v97
    v_cvt_pk_bf16_f32 v197, v98, v99
    v_cvt_pk_bf16_f32 v198, v116, v117
    v_cvt_pk_bf16_f32 v199, v118, v119
    v_cvt_pk_bf16_f32 v200, v136, v137
    v_cvt_pk_bf16_f32 v201, v138, v139
    v_cvt_pk_bf16_f32 v202, v156, v157
    v_cvt_pk_bf16_f32 v203, v158, v159
    v_cvt_pk_bf16_f32 v204, v100, v101
    v_cvt_pk_bf16_f32 v205, v102, v103
    v_cvt_pk_bf16_f32 v206, v120, v121
    v_cvt_pk_bf16_f32 v207, v122, v123
    v_cvt_pk_bf16_f32 v208, v140, v141
    v_cvt_pk_bf16_f32 v209, v142, v143
    v_cvt_pk_bf16_f32 v210, v160, v161
    v_cvt_pk_bf16_f32 v211, v162, v163
    v_cvt_pk_bf16_f32 v212, v104, v105
    v_cvt_pk_bf16_f32 v213, v106, v107
    v_cvt_pk_bf16_f32 v214, v124, v125
    v_cvt_pk_bf16_f32 v215, v126, v127
    v_cvt_pk_bf16_f32 v216, v144, v145
    v_cvt_pk_bf16_f32 v217, v146, v147
    v_cvt_pk_bf16_f32 v218, v164, v165
    v_cvt_pk_bf16_f32 v219, v166, v167
    s_branch concat_heads__sliding_block__grouped_kv_mqa__prompt_kernel_b
concat_heads__sliding_block__grouped_kv_mqa__prompt_kernel_c_qk:
    ds_read_b128 v[180:183], v76 offset:0
    ds_read_b64_tr_b16 v[212:213], v78 offset:0
    ds_read_b64_tr_b16 v[214:215], v78 offset:1280
    ds_read_b64_tr_b16 v[216:217], v79 offset:0
    ds_read_b64_tr_b16 v[218:219], v79 offset:1280
    ds_read_b128 v[184:187], v76 offset:2048
    ds_read_b64_tr_b16 v[220:221], v80 offset:0
    ds_read_b64_tr_b16 v[222:223], v80 offset:1280
    ds_read_b64_tr_b16 v[224:225], v81 offset:0
    ds_read_b64_tr_b16 v[226:227], v81 offset:1280
    ds_read_b64_tr_b16 v[228:229], v82 offset:0
    ds_read_b64_tr_b16 v[230:231], v82 offset:1280
    ds_read_b128 v[188:191], v76 offset:4096
    ds_read_b128 v[192:195], v76 offset:6144
.p2align 6
concat_heads__sliding_block__grouped_kv_mqa__prompt_kernel_c_qk_loop:
    s_waitcnt lgkmcnt(0)
    v_mfma_f32_16x16x32_bf16 v[88:91], v[212:215], v[180:183], v[88:91]
    ds_read_b128 v[196:199], v77 offset:0
    ds_read_b64_tr_b16 v[232:233], v78 offset:10240
    v_mfma_f32_16x16x32_bf16 v[92:95], v[216:219], v[180:183], v[92:95]
    ds_read_b64_tr_b16 v[234:235], v78 offset:11520
    ds_read_b64_tr_b16 v[236:237], v79 offset:10240
    v_mfma_f32_16x16x32_bf16 v[96:99], v[220:223], v[180:183], v[96:99]
    ds_read_b64_tr_b16 v[238:239], v79 offset:11520
    ds_read_b128 v[200:203], v77 offset:2048
    v_mfma_f32_16x16x32_bf16 v[100:103], v[224:227], v[180:183], v[100:103]
    ds_read_b64_tr_b16 v[240:241], v80 offset:10240
    ds_read_b64_tr_b16 v[242:243], v80 offset:11520
    v_mfma_f32_16x16x32_bf16 v[104:107], v[228:231], v[180:183], v[104:107]
    ds_read_b64_tr_b16 v[244:245], v81 offset:10240
    ds_read_b64_tr_b16 v[246:247], v81 offset:11520
    v_mfma_f32_16x16x32_bf16 v[108:111], v[212:215], v[184:187], v[108:111]
    ds_read_b64_tr_b16 v[248:249], v82 offset:10240
    ds_read_b64_tr_b16 v[250:251], v82 offset:11520
    v_mfma_f32_16x16x32_bf16 v[112:115], v[216:219], v[184:187], v[112:115]
    ds_read_b128 v[204:207], v77 offset:4096
    ds_read_b128 v[208:211], v77 offset:6144
    v_mfma_f32_16x16x32_bf16 v[116:119], v[220:223], v[184:187], v[116:119]
    s_add_u32 s43, s43, 1
    s_and_b32 s43, s43, 3
    v_mfma_f32_16x16x32_bf16 v[120:123], v[224:227], v[184:187], v[120:123]
    s_cselect_b32 s42, 0, 4294819840
    s_add_u32 s42, s42, 36864
    v_mfma_f32_16x16x32_bf16 v[124:127], v[228:231], v[184:187], v[124:127]
    v_add_u32 v76, s42, v76
    v_mfma_f32_16x16x32_bf16 v[128:131], v[212:215], v[188:191], v[128:131]
    v_add_u32 v77, s42, v77
    v_mfma_f32_16x16x32_bf16 v[132:135], v[216:219], v[188:191], v[132:135]
    v_add_u32 v78, s42, v78
    v_mfma_f32_16x16x32_bf16 v[136:139], v[220:223], v[188:191], v[136:139]
    v_add_u32 v79, s42, v79
    v_mfma_f32_16x16x32_bf16 v[140:143], v[224:227], v[188:191], v[140:143]
    v_add_u32 v80, s42, v80
    v_mfma_f32_16x16x32_bf16 v[144:147], v[228:231], v[188:191], v[144:147]
    v_add_u32 v81, s42, v81
    v_mfma_f32_16x16x32_bf16 v[148:151], v[212:215], v[192:195], v[148:151]
    v_add_u32 v82, s42, v82
    v_mfma_f32_16x16x32_bf16 v[152:155], v[216:219], v[192:195], v[152:155]
    v_mfma_f32_16x16x32_bf16 v[156:159], v[220:223], v[192:195], v[156:159]
    v_mfma_f32_16x16x32_bf16 v[160:163], v[224:227], v[192:195], v[160:163]
    v_mfma_f32_16x16x32_bf16 v[164:167], v[228:231], v[192:195], v[164:167]
    s_waitcnt lgkmcnt(0)
    s_barrier
    v_mfma_f32_16x16x32_bf16 v[88:91], v[232:235], v[196:199], v[88:91]
    ds_read_b128 v[180:183], v76 offset:0
    ds_read_b64_tr_b16 v[212:213], v78 offset:0
    v_mfma_f32_16x16x32_bf16 v[92:95], v[236:239], v[196:199], v[92:95]
    ds_read_b64_tr_b16 v[214:215], v78 offset:1280
    ds_read_b64_tr_b16 v[216:217], v79 offset:0
    v_mfma_f32_16x16x32_bf16 v[96:99], v[240:243], v[196:199], v[96:99]
    ds_read_b64_tr_b16 v[218:219], v79 offset:1280
    ds_read_b128 v[184:187], v76 offset:2048
    v_mfma_f32_16x16x32_bf16 v[100:103], v[244:247], v[196:199], v[100:103]
    ds_read_b64_tr_b16 v[220:221], v80 offset:0
    ds_read_b64_tr_b16 v[222:223], v80 offset:1280
    v_mfma_f32_16x16x32_bf16 v[104:107], v[248:251], v[196:199], v[104:107]
    ds_read_b64_tr_b16 v[224:225], v81 offset:0
    ds_read_b64_tr_b16 v[226:227], v81 offset:1280
    v_mfma_f32_16x16x32_bf16 v[108:111], v[232:235], v[200:203], v[108:111]
    ds_read_b64_tr_b16 v[228:229], v82 offset:0
    ds_read_b64_tr_b16 v[230:231], v82 offset:1280
    v_mfma_f32_16x16x32_bf16 v[112:115], v[236:239], v[200:203], v[112:115]
    ds_read_b128 v[188:191], v76 offset:4096
    ds_read_b128 v[192:195], v76 offset:6144
    v_mfma_f32_16x16x32_bf16 v[116:119], v[240:243], v[200:203], v[116:119]
    v_mfma_f32_16x16x32_bf16 v[120:123], v[244:247], v[200:203], v[120:123]
    v_mfma_f32_16x16x32_bf16 v[124:127], v[248:251], v[200:203], v[124:127]
    v_mfma_f32_16x16x32_bf16 v[128:131], v[232:235], v[204:207], v[128:131]
    v_mfma_f32_16x16x32_bf16 v[132:135], v[236:239], v[204:207], v[132:135]
    v_mfma_f32_16x16x32_bf16 v[136:139], v[240:243], v[204:207], v[136:139]
    v_mfma_f32_16x16x32_bf16 v[140:143], v[244:247], v[204:207], v[140:143]
    v_mfma_f32_16x16x32_bf16 v[144:147], v[248:251], v[204:207], v[144:147]
    v_mfma_f32_16x16x32_bf16 v[148:151], v[232:235], v[208:211], v[148:151]
    v_mfma_f32_16x16x32_bf16 v[152:155], v[236:239], v[208:211], v[152:155]
    v_mfma_f32_16x16x32_bf16 v[156:159], v[240:243], v[208:211], v[156:159]
    v_mfma_f32_16x16x32_bf16 v[160:163], v[244:247], v[208:211], v[160:163]
    v_mfma_f32_16x16x32_bf16 v[164:167], v[248:251], v[208:211], v[164:167]
    s_sub_u32 s94, s94, 1
    s_cmp_lg_u32 s94, 0
    s_cbranch_scc1 concat_heads__sliding_block__grouped_kv_mqa__prompt_kernel_c_qk_loop
    s_mov_b32 s2, 0x3ea52b5c
    s_mov_b32 s3, s2
    s_cmp_eq_u32 s38, 1
    s_waitcnt lgkmcnt(0)
    s_cbranch_scc1 concat_heads__sliding_block__grouped_kv_mqa__prompt_kernel_e_k
    v_pk_mul_f32 v[88:89], v[88:89], s[2:3]
    v_pk_mul_f32 v[90:91], v[90:91], s[2:3]
    v_pk_mul_f32 v[92:93], v[92:93], s[2:3]
    v_pk_mul_f32 v[94:95], v[94:95], s[2:3]
    v_pk_mul_f32 v[96:97], v[96:97], s[2:3]
    v_pk_mul_f32 v[98:99], v[98:99], s[2:3]
    v_pk_mul_f32 v[100:101], v[100:101], s[2:3]
    v_pk_mul_f32 v[102:103], v[102:103], s[2:3]
    v_pk_mul_f32 v[104:105], v[104:105], s[2:3]
    v_pk_mul_f32 v[106:107], v[106:107], s[2:3]
    v_pk_mul_f32 v[108:109], v[108:109], s[2:3]
    v_pk_mul_f32 v[110:111], v[110:111], s[2:3]
    v_pk_mul_f32 v[112:113], v[112:113], s[2:3]
    v_pk_mul_f32 v[114:115], v[114:115], s[2:3]
    v_pk_mul_f32 v[116:117], v[116:117], s[2:3]
    v_pk_mul_f32 v[118:119], v[118:119], s[2:3]
    v_pk_mul_f32 v[120:121], v[120:121], s[2:3]
    v_pk_mul_f32 v[122:123], v[122:123], s[2:3]
    v_pk_mul_f32 v[124:125], v[124:125], s[2:3]
    v_pk_mul_f32 v[126:127], v[126:127], s[2:3]
    v_pk_mul_f32 v[128:129], v[128:129], s[2:3]
    v_pk_mul_f32 v[130:131], v[130:131], s[2:3]
    v_pk_mul_f32 v[132:133], v[132:133], s[2:3]
    v_pk_mul_f32 v[134:135], v[134:135], s[2:3]
    v_pk_mul_f32 v[136:137], v[136:137], s[2:3]
    v_pk_mul_f32 v[138:139], v[138:139], s[2:3]
    v_pk_mul_f32 v[140:141], v[140:141], s[2:3]
    v_pk_mul_f32 v[142:143], v[142:143], s[2:3]
    v_pk_mul_f32 v[144:145], v[144:145], s[2:3]
    v_pk_mul_f32 v[146:147], v[146:147], s[2:3]
    v_pk_mul_f32 v[148:149], v[148:149], s[2:3]
    v_pk_mul_f32 v[150:151], v[150:151], s[2:3]
    v_pk_mul_f32 v[152:153], v[152:153], s[2:3]
    v_pk_mul_f32 v[154:155], v[154:155], s[2:3]
    v_pk_mul_f32 v[156:157], v[156:157], s[2:3]
    v_pk_mul_f32 v[158:159], v[158:159], s[2:3]
    v_pk_mul_f32 v[160:161], v[160:161], s[2:3]
    v_pk_mul_f32 v[162:163], v[162:163], s[2:3]
    v_pk_mul_f32 v[164:165], v[164:165], s[2:3]
    v_pk_mul_f32 v[166:167], v[166:167], s[2:3]
concat_heads__sliding_block__grouped_kv_mqa__prompt_kernel_e_k:
    v_cvt_pk_bf16_f32 v180, v88, v89
    v_cvt_pk_bf16_f32 v181, v90, v91
    v_cvt_pk_bf16_f32 v182, v92, v93
    v_cvt_pk_bf16_f32 v183, v94, v95
    v_cvt_pk_bf16_f32 v184, v96, v97
    v_cvt_pk_bf16_f32 v185, v98, v99
    v_cvt_pk_bf16_f32 v186, v100, v101
    v_cvt_pk_bf16_f32 v187, v102, v103
    v_cvt_pk_bf16_f32 v188, v104, v105
    v_cvt_pk_bf16_f32 v189, v106, v107
    v_cvt_pk_bf16_f32 v190, v108, v109
    v_cvt_pk_bf16_f32 v191, v110, v111
    v_cvt_pk_bf16_f32 v192, v112, v113
    v_cvt_pk_bf16_f32 v193, v114, v115
    v_cvt_pk_bf16_f32 v194, v116, v117
    v_cvt_pk_bf16_f32 v195, v118, v119
    v_cvt_pk_bf16_f32 v196, v120, v121
    v_cvt_pk_bf16_f32 v197, v122, v123
    v_cvt_pk_bf16_f32 v198, v124, v125
    v_cvt_pk_bf16_f32 v199, v126, v127
    v_cvt_pk_bf16_f32 v200, v128, v129
    v_cvt_pk_bf16_f32 v201, v130, v131
    v_cvt_pk_bf16_f32 v202, v132, v133
    v_cvt_pk_bf16_f32 v203, v134, v135
    v_cvt_pk_bf16_f32 v204, v136, v137
    v_cvt_pk_bf16_f32 v205, v138, v139
    v_cvt_pk_bf16_f32 v206, v140, v141
    v_cvt_pk_bf16_f32 v207, v142, v143
    v_cvt_pk_bf16_f32 v208, v144, v145
    v_cvt_pk_bf16_f32 v209, v146, v147
    v_cvt_pk_bf16_f32 v210, v148, v149
    v_cvt_pk_bf16_f32 v211, v150, v151
    v_cvt_pk_bf16_f32 v212, v152, v153
    v_cvt_pk_bf16_f32 v213, v154, v155
    v_cvt_pk_bf16_f32 v214, v156, v157
    v_cvt_pk_bf16_f32 v215, v158, v159
    v_cvt_pk_bf16_f32 v216, v160, v161
    v_cvt_pk_bf16_f32 v217, v162, v163
    v_cvt_pk_bf16_f32 v218, v164, v165
    v_cvt_pk_bf16_f32 v219, v166, v167
concat_heads__sliding_block__grouped_kv_mqa__prompt_kernel_b:
    s_nop 1
    ds_read_b128 v[240:243], v83 offset:0
    ds_read_b128 v[244:247], v83 offset:2048
    ds_read_b64_tr_b16 v[220:221], v84 offset:0
    ds_read_b64_tr_b16 v[222:223], v84 offset:1280
    ds_read_b64_tr_b16 v[224:225], v84 offset:8
    ds_read_b64_tr_b16 v[226:227], v84 offset:1288
    ds_read_b64_tr_b16 v[228:229], v84 offset:16
    ds_read_b64_tr_b16 v[230:231], v84 offset:1296
    ds_read_b64_tr_b16 v[232:233], v84 offset:24
    ds_read_b64_tr_b16 v[234:235], v84 offset:1304
    ds_read_b64_tr_b16 v[236:237], v84 offset:32
    ds_read_b64_tr_b16 v[238:239], v84 offset:1312
    v_mov_b32 v88, 0
    v_mov_b32 v89, 0
    v_mov_b32 v90, 0
    v_mov_b32 v91, 0
    v_mov_b32 v92, 0
    v_mov_b32 v93, 0
    v_mov_b32 v94, 0
    v_mov_b32 v95, 0
    v_mov_b32 v96, 0
    v_mov_b32 v97, 0
    v_mov_b32 v98, 0
    v_mov_b32 v99, 0
    v_mov_b32 v100, 0
    v_mov_b32 v101, 0
    v_mov_b32 v102, 0
    v_mov_b32 v103, 0
    v_mov_b32 v104, 0
    v_mov_b32 v105, 0
    v_mov_b32 v106, 0
    v_mov_b32 v107, 0
    v_mov_b32 v108, 0
    v_mov_b32 v109, 0
    v_mov_b32 v110, 0
    v_mov_b32 v111, 0
    v_mov_b32 v112, 0
    v_mov_b32 v113, 0
    v_mov_b32 v114, 0
    v_mov_b32 v115, 0
    v_mov_b32 v116, 0
    v_mov_b32 v117, 0
    v_mov_b32 v118, 0
    v_mov_b32 v119, 0
    v_mov_b32 v120, 0
    v_mov_b32 v121, 0
    v_mov_b32 v122, 0
    v_mov_b32 v123, 0
    v_mov_b32 v124, 0
    v_mov_b32 v125, 0
    v_mov_b32 v126, 0
    v_mov_b32 v127, 0
    v_mov_b32 v176, 0
    v_mov_b32 v177, 0
    v_mov_b32 v178, 0
    v_mov_b32 v179, 0
    s_mov_b32 s94, 5
concat_heads__sliding_block__grouped_kv_mqa__prompt_kernel_b_loop:
    s_movk_i32 s42, 18432
    s_waitcnt lgkmcnt(0)
    s_barrier
    v_add_u32 v83, s42, v83
    v_add_u32 v84, s42, v84
    v_mfma_f32_16x16x32_bf16 v[88:91], v[220:223], v[240:243], v[88:91]
    ds_read_b128 v[148:151], v83 offset:0
    ds_read_b128 v[152:155], v83 offset:2048
    v_mfma_f32_16x16x32_bf16 v[108:111], v[220:223], v[244:247], v[108:111]
    ds_read_b64_tr_b16 v[128:129], v84 offset:0
    ds_read_b64_tr_b16 v[130:131], v84 offset:1280
    v_mfma_f32_16x16x32_bf16 v[92:95], v[224:227], v[240:243], v[92:95]
    ds_read_b64_tr_b16 v[132:133], v84 offset:8
    ds_read_b64_tr_b16 v[134:135], v84 offset:1288
    v_mfma_f32_16x16x32_bf16 v[112:115], v[224:227], v[244:247], v[112:115]
    ds_read_b64_tr_b16 v[136:137], v84 offset:16
    ds_read_b64_tr_b16 v[138:139], v84 offset:1296
    v_mfma_f32_16x16x32_bf16 v[96:99], v[228:231], v[240:243], v[96:99]
    ds_read_b64_tr_b16 v[140:141], v84 offset:24
    ds_read_b64_tr_b16 v[142:143], v84 offset:1304
    v_mfma_f32_16x16x32_bf16 v[116:119], v[228:231], v[244:247], v[116:119]
    ds_read_b64_tr_b16 v[144:145], v84 offset:32
    ds_read_b64_tr_b16 v[146:147], v84 offset:1312
    v_mfma_f32_16x16x32_bf16 v[100:103], v[232:235], v[240:243], v[100:103]
    v_mfma_f32_16x16x32_bf16 v[120:123], v[232:235], v[244:247], v[120:123]
    v_mfma_f32_16x16x32_bf16 v[104:107], v[236:239], v[240:243], v[104:107]
    v_mfma_f32_16x16x32_bf16 v[124:127], v[236:239], v[244:247], v[124:127]
    s_cmp_eq_u32 s94, 2
    s_cselect_b32 s42, 4294893568, s42
    s_waitcnt lgkmcnt(0)
    s_barrier
    v_add_u32 v83, s42, v83
    v_add_u32 v84, s42, v84
    v_mfma_f32_16x16x32_bf16 v[88:91], v[128:131], v[148:151], v[88:91]
    ds_read_b128 v[240:243], v83 offset:0
    ds_read_b128 v[244:247], v83 offset:2048
    v_mfma_f32_16x16x32_bf16 v[108:111], v[128:131], v[152:155], v[108:111]
    ds_read_b64_tr_b16 v[220:221], v84 offset:0
    ds_read_b64_tr_b16 v[222:223], v84 offset:1280
    v_mfma_f32_16x16x32_bf16 v[92:95], v[132:135], v[148:151], v[92:95]
    ds_read_b64_tr_b16 v[224:225], v84 offset:8
    ds_read_b64_tr_b16 v[226:227], v84 offset:1288
    v_mfma_f32_16x16x32_bf16 v[112:115], v[132:135], v[152:155], v[112:115]
    ds_read_b64_tr_b16 v[228:229], v84 offset:16
    ds_read_b64_tr_b16 v[230:231], v84 offset:1296
    v_mfma_f32_16x16x32_bf16 v[96:99], v[136:139], v[148:151], v[96:99]
    ds_read_b64_tr_b16 v[232:233], v84 offset:24
    ds_read_b64_tr_b16 v[234:235], v84 offset:1304
    v_mfma_f32_16x16x32_bf16 v[116:119], v[136:139], v[152:155], v[116:119]
    ds_read_b64_tr_b16 v[236:237], v84 offset:32
    ds_read_b64_tr_b16 v[238:239], v84 offset:1312
    v_mfma_f32_16x16x32_bf16 v[100:103], v[140:143], v[148:151], v[100:103]
    v_mfma_f32_16x16x32_bf16 v[120:123], v[140:143], v[152:155], v[120:123]
    v_mfma_f32_16x16x32_bf16 v[104:107], v[144:147], v[148:151], v[104:107]
    v_mfma_f32_16x16x32_bf16 v[124:127], v[144:147], v[152:155], v[124:127]
    s_sub_u32 s94, s94, 1
    s_cmp_lg_u32 s94, 0
    s_cbranch_scc1 concat_heads__sliding_block__grouped_kv_mqa__prompt_kernel_b_loop
    s_xor_b32 s2, s36, 2
    s_mul_i32 s2, s2, 5120
    s_add_u32 s2, s2, 58368
    v_add_u32 v12, s2, v2
    s_mul_i32 s2, s36, 5120
    s_add_u32 s2, s2, 58368
    v_add_u32 v13, s2, v2
    v_and_b32 v7, 15, v0
    v_lshrrev_b32 v8, 4, v0
    v_mul_u32_u24 v8, 2560, v8
    s_and_b32 s44, s36, 1
    s_mul_i32 s44, s44, 1280
    s_add_u32 s44, s44, 147456
    s_lshr_b32 s45, s36, 1
    s_lshl_b32 s45, s45, 4
    s_mov_b32 s2, 0x3ea52b5c
    s_mov_b32 s3, 0x3ea52b5c
    s_cmp_ge_u32 s36, 2
    s_cbranch_scc1 concat_heads__sliding_block__grouped_kv_mqa__prompt_kernel_b_x1
concat_heads__sliding_block__grouped_kv_mqa__prompt_kernel_b_x0:
    ds_write_b128 v12, v[108:111] offset:0
    ds_write_b128 v12, v[112:115] offset:1024
    ds_write_b128 v12, v[116:119] offset:2048
    ds_write_b128 v12, v[120:123] offset:3072
    ds_write_b128 v12, v[124:127] offset:4096
    v_add_u32 v7, s45, v7
    v_add_u32 v8, s44, v8
    v_lshl_add_u32 v10, v7, 4, v8
    v_lshl_add_u32 v11, v7, 3, v8
    s_waitcnt lgkmcnt(0)
    s_barrier
    ds_read_b128 v[108:111], v13 offset:0
    ds_read_b128 v[112:115], v13 offset:1024
    ds_read_b128 v[116:119], v13 offset:2048
    ds_read_b128 v[120:123], v13 offset:3072
    ds_read_b128 v[124:127], v13 offset:4096
    s_waitcnt lgkmcnt(4)
    v_pk_add_f32 v[88:89], v[88:89], v[108:109]
    v_pk_add_f32 v[90:91], v[90:91], v[110:111]
    v_pk_mul_f32 v[88:89], v[88:89], s[2:3]
    v_pk_mul_f32 v[90:91], v[90:91], s[2:3]
    v_cvt_pk_bf16_f32 v220, v88, v89
    v_cvt_pk_bf16_f32 v221, v90, v91
    s_waitcnt lgkmcnt(3)
    v_pk_add_f32 v[92:93], v[92:93], v[112:113]
    v_pk_add_f32 v[94:95], v[94:95], v[114:115]
    v_pk_mul_f32 v[92:93], v[92:93], s[2:3]
    v_pk_mul_f32 v[94:95], v[94:95], s[2:3]
    v_cvt_pk_bf16_f32 v222, v92, v93
    v_cvt_pk_bf16_f32 v223, v94, v95
    ds_write_b128 v10, v[220:223]
    s_waitcnt lgkmcnt(3)
    v_pk_add_f32 v[96:97], v[96:97], v[116:117]
    v_pk_add_f32 v[98:99], v[98:99], v[118:119]
    v_pk_mul_f32 v[96:97], v[96:97], s[2:3]
    v_pk_mul_f32 v[98:99], v[98:99], s[2:3]
    v_cvt_pk_bf16_f32 v224, v96, v97
    v_cvt_pk_bf16_f32 v225, v98, v99
    s_waitcnt lgkmcnt(2)
    v_pk_add_f32 v[100:101], v[100:101], v[120:121]
    v_pk_add_f32 v[102:103], v[102:103], v[122:123]
    v_pk_mul_f32 v[100:101], v[100:101], s[2:3]
    v_pk_mul_f32 v[102:103], v[102:103], s[2:3]
    v_cvt_pk_bf16_f32 v226, v100, v101
    v_cvt_pk_bf16_f32 v227, v102, v103
    ds_write_b128 v10, v[224:227] offset:512
    s_waitcnt lgkmcnt(2)
    v_pk_add_f32 v[104:105], v[104:105], v[124:125]
    v_pk_add_f32 v[106:107], v[106:107], v[126:127]
    v_pk_mul_f32 v[104:105], v[104:105], s[2:3]
    v_pk_mul_f32 v[106:107], v[106:107], s[2:3]
    v_cvt_pk_bf16_f32 v228, v104, v105
    v_cvt_pk_bf16_f32 v229, v106, v107
    ds_write_b64 v11, v[228:229] offset:1024
    s_branch concat_heads__sliding_block__grouped_kv_mqa__prompt_kernel_b_y
concat_heads__sliding_block__grouped_kv_mqa__prompt_kernel_b_x1:
    ds_write_b128 v12, v[88:91] offset:0
    ds_write_b128 v12, v[92:95] offset:1024
    ds_write_b128 v12, v[96:99] offset:2048
    ds_write_b128 v12, v[100:103] offset:3072
    ds_write_b128 v12, v[104:107] offset:4096
    v_add_u32 v7, s45, v7
    v_add_u32 v8, s44, v8
    v_lshl_add_u32 v10, v7, 4, v8
    v_lshl_add_u32 v11, v7, 3, v8
    s_waitcnt lgkmcnt(0)
    s_barrier
    ds_read_b128 v[88:91], v13 offset:0
    ds_read_b128 v[92:95], v13 offset:1024
    ds_read_b128 v[96:99], v13 offset:2048
    ds_read_b128 v[100:103], v13 offset:3072
    ds_read_b128 v[104:107], v13 offset:4096
    s_waitcnt lgkmcnt(4)
    v_pk_add_f32 v[108:109], v[108:109], v[88:89]
    v_pk_add_f32 v[110:111], v[110:111], v[90:91]
    v_pk_mul_f32 v[108:109], v[108:109], s[2:3]
    v_pk_mul_f32 v[110:111], v[110:111], s[2:3]
    v_cvt_pk_bf16_f32 v220, v108, v109
    v_cvt_pk_bf16_f32 v221, v110, v111
    s_waitcnt lgkmcnt(3)
    v_pk_add_f32 v[112:113], v[112:113], v[92:93]
    v_pk_add_f32 v[114:115], v[114:115], v[94:95]
    v_pk_mul_f32 v[112:113], v[112:113], s[2:3]
    v_pk_mul_f32 v[114:115], v[114:115], s[2:3]
    v_cvt_pk_bf16_f32 v222, v112, v113
    v_cvt_pk_bf16_f32 v223, v114, v115
    ds_write_b128 v10, v[220:223]
    s_waitcnt lgkmcnt(3)
    v_pk_add_f32 v[116:117], v[116:117], v[96:97]
    v_pk_add_f32 v[118:119], v[118:119], v[98:99]
    v_pk_mul_f32 v[116:117], v[116:117], s[2:3]
    v_pk_mul_f32 v[118:119], v[118:119], s[2:3]
    v_cvt_pk_bf16_f32 v224, v116, v117
    v_cvt_pk_bf16_f32 v225, v118, v119
    s_waitcnt lgkmcnt(2)
    v_pk_add_f32 v[120:121], v[120:121], v[100:101]
    v_pk_add_f32 v[122:123], v[122:123], v[102:103]
    v_pk_mul_f32 v[120:121], v[120:121], s[2:3]
    v_pk_mul_f32 v[122:123], v[122:123], s[2:3]
    v_cvt_pk_bf16_f32 v226, v120, v121
    v_cvt_pk_bf16_f32 v227, v122, v123
    ds_write_b128 v10, v[224:227] offset:512
    s_waitcnt lgkmcnt(2)
    v_pk_add_f32 v[124:125], v[124:125], v[104:105]
    v_pk_add_f32 v[126:127], v[126:127], v[106:107]
    v_pk_mul_f32 v[124:125], v[124:125], s[2:3]
    v_pk_mul_f32 v[126:127], v[126:127], s[2:3]
    v_cvt_pk_bf16_f32 v228, v124, v125
    v_cvt_pk_bf16_f32 v229, v126, v127
    ds_write_b64 v11, v[228:229] offset:1024
concat_heads__sliding_block__grouped_kv_mqa__prompt_kernel_b_y:
    s_setprio 0
    s_waitcnt lgkmcnt(0)
concat_heads__sliding_block__grouped_kv_mqa__prompt_kernel_x1:
    s_barrier
    s_mul_i32 s2, s100, 1280
    s_xor_b32 s3, s2, 1280
    v_add_u32 v7, s2, v22
    v_add_u32 v8, s2, v23
    v_add_u32 v10, s3, v22
    v_add_u32 v11, s3, v23
    ds_read_b128 v[30:33], v7
    s_mov_b32 exec_hi, 0
    ds_read_b64 v[34:35], v8 offset:1024
    ds_read_b64 v[40:41], v11 offset:1024
    s_mov_b32 exec_hi, -1
    ds_read_b128 v[152:155], v14 offset:0
    ds_read_b64 v[156:157], v15 offset:0
    ds_read_b128 v[36:39], v10
    ds_read_b128 v[164:167], v16 offset:0
    ds_read_b128 v[168:171], v16 offset:768
    ds_read_b128 v[158:161], v14 offset:2816
    ds_read_b64 v[162:163], v15 offset:2816
    s_cmp_ge_u32 s36, 4
    s_cbranch_scc1 concat_heads__sliding_block__grouped_kv_mqa__prompt_kernel_noz
    s_setprio 0
    v_mov_b32 v88, 0
    v_mov_b32 v89, 0
    v_mov_b32 v90, 0
    v_mov_b32 v91, 0
    v_mov_b32 v92, 0
    v_mov_b32 v93, 0
    v_mov_b32 v94, 0
    v_mov_b32 v95, 0
    v_mov_b32 v96, 0
    v_mov_b32 v97, 0
    v_mov_b32 v98, 0
    v_mov_b32 v99, 0
    v_mov_b32 v100, 0
    v_mov_b32 v101, 0
    v_mov_b32 v102, 0
    v_mov_b32 v103, 0
    v_mov_b32 v104, 0
    v_mov_b32 v105, 0
    v_mov_b32 v106, 0
    v_mov_b32 v107, 0
    v_mov_b32 v108, 0
    v_mov_b32 v109, 0
    v_mov_b32 v110, 0
    v_mov_b32 v111, 0
    v_mov_b32 v112, 0
    v_mov_b32 v113, 0
    v_mov_b32 v114, 0
    v_mov_b32 v115, 0
    v_mov_b32 v116, 0
    v_mov_b32 v117, 0
    v_mov_b32 v118, 0
    v_mov_b32 v119, 0
    v_mov_b32 v144, 0
    v_mov_b32 v145, 0
    v_mov_b32 v146, 0
    v_mov_b32 v147, 0
    v_mov_b32 v148, 0
    v_mov_b32 v149, 0
    v_mov_b32 v150, 0
    v_mov_b32 v151, 0
concat_heads__sliding_block__grouped_kv_mqa__prompt_kernel_noz:
    s_add_u32 s4, s20, 5767168
    s_addc_u32 s5, s21, 0
    s_mov_b32 s6, 180224
    s_mov_b32 s7, 0x00020000
    s_mov_b32 s94, 0
    s_waitcnt lgkmcnt(4)
    v_mfma_f32_32x32x8bf16_1k v[120:135], v[156:157], v[34:35], 0
    v_mfma_f32_32x32x16_bf16 v[120:135], v[152:155], v[30:33], v[120:135]
    s_nop 7
    s_nop 2
.p2align 6
concat_heads__sliding_block__grouped_kv_mqa__prompt_kernel_bloop:
    v_smfmac_f32_32x32x32_bf16 v[104:119], v[176:179], v[144:151], v1
    v_exp_f32 v120, v120
    v_exp_f32 v121, v121
    v_exp_f32 v122, v122
    v_exp_f32 v123, v123
    v_mfma_f32_32x32x8bf16_1k v[136:151], v[156:157], v[40:41], 0
    v_exp_f32 v124, v124
    v_exp_f32 v125, v125
    v_exp_f32 v126, v126
    v_exp_f32 v127, v127
    v_mfma_f32_32x32x16_bf16 v[136:151], v[152:155], v[36:39], v[136:151]
    v_exp_f32 v128, v128
    v_exp_f32 v129, v129
    v_exp_f32 v130, v130
    v_exp_f32 v131, v131
    s_waitcnt lgkmcnt(0)
    v_smfmac_f32_32x32x32_bf16 v[88:103], v[164:167], v[120:127], v1
    v_exp_f32 v132, v132
    v_exp_f32 v133, v133
    v_exp_f32 v134, v134
    v_exp_f32 v135, v135
    ds_read_b128 v[172:175], v16 offset:2816
    ds_read_b128 v[176:179], v16 offset:3584
    v_smfmac_f32_32x32x32_bf16 v[88:103], v[168:171], v[128:135], v1
    v_exp_f32 v136, v136
    v_exp_f32 v137, v137
    v_exp_f32 v138, v138
    v_exp_f32 v139, v139
    v_mfma_f32_32x32x8bf16_1k v[120:135], v[162:163], v[34:35], 0
    v_exp_f32 v140, v140
    v_exp_f32 v141, v141
    v_exp_f32 v142, v142
    v_exp_f32 v143, v143
    v_mfma_f32_32x32x16_bf16 v[120:135], v[158:161], v[30:33], v[120:135]
    v_exp_f32 v144, v144
    v_exp_f32 v145, v145
    v_exp_f32 v146, v146
    v_exp_f32 v147, v147
    v_smfmac_f32_32x32x32_bf16 v[104:119], v[164:167], v[136:143], v1
    v_exp_f32 v148, v148
    v_exp_f32 v149, v149
    v_exp_f32 v150, v150
    v_exp_f32 v151, v151
    ds_read_b128 v[152:155], v14 offset:5632
    ds_read_b64 v[156:157], v15 offset:5632
    v_smfmac_f32_32x32x32_bf16 v[104:119], v[168:171], v[144:151], v1
    v_exp_f32 v120, v120
    v_exp_f32 v121, v121
    v_exp_f32 v122, v122
    v_exp_f32 v123, v123
    v_mfma_f32_32x32x8bf16_1k v[136:151], v[162:163], v[40:41], 0
    v_exp_f32 v124, v124
    v_exp_f32 v125, v125
    v_exp_f32 v126, v126
    v_exp_f32 v127, v127
    v_mfma_f32_32x32x16_bf16 v[136:151], v[158:161], v[36:39], v[136:151]
    v_exp_f32 v128, v128
    v_exp_f32 v129, v129
    v_exp_f32 v130, v130
    v_exp_f32 v131, v131
    s_waitcnt lgkmcnt(0)
    v_smfmac_f32_32x32x32_bf16 v[88:103], v[172:175], v[120:127], v1
    v_exp_f32 v132, v132
    v_exp_f32 v133, v133
    v_exp_f32 v134, v134
    v_exp_f32 v135, v135
    ds_read_b128 v[164:167], v16 offset:5632
    ds_read_b128 v[168:171], v16 offset:6400
    v_smfmac_f32_32x32x32_bf16 v[88:103], v[176:179], v[128:135], v1
    v_exp_f32 v136, v136
    v_exp_f32 v137, v137
    v_exp_f32 v138, v138
    v_exp_f32 v139, v139
    v_mfma_f32_32x32x8bf16_1k v[120:135], v[156:157], v[34:35], 0
    v_exp_f32 v140, v140
    v_exp_f32 v141, v141
    v_exp_f32 v142, v142
    v_exp_f32 v143, v143
    v_mfma_f32_32x32x16_bf16 v[120:135], v[152:155], v[30:33], v[120:135]
    v_exp_f32 v144, v144
    v_exp_f32 v145, v145
    v_exp_f32 v146, v146
    v_exp_f32 v147, v147
    v_smfmac_f32_32x32x32_bf16 v[104:119], v[172:175], v[136:143], v1
    v_exp_f32 v148, v148
    v_exp_f32 v149, v149
    v_exp_f32 v150, v150
    v_exp_f32 v151, v151
    ds_read_b128 v[158:161], v14 offset:8448
    ds_read_b64 v[162:163], v15 offset:8448
    v_smfmac_f32_32x32x32_bf16 v[104:119], v[176:179], v[144:151], v1
    v_exp_f32 v120, v120
    v_exp_f32 v121, v121
    v_exp_f32 v122, v122
    v_exp_f32 v123, v123
    v_mfma_f32_32x32x8bf16_1k v[136:151], v[156:157], v[40:41], 0
    v_exp_f32 v124, v124
    v_exp_f32 v125, v125
    v_exp_f32 v126, v126
    v_exp_f32 v127, v127
    v_mfma_f32_32x32x16_bf16 v[136:151], v[152:155], v[36:39], v[136:151]
    v_exp_f32 v128, v128
    v_exp_f32 v129, v129
    v_exp_f32 v130, v130
    v_exp_f32 v131, v131
    s_waitcnt lgkmcnt(0)
    v_smfmac_f32_32x32x32_bf16 v[88:103], v[164:167], v[120:127], v1
    v_exp_f32 v132, v132
    v_exp_f32 v133, v133
    v_exp_f32 v134, v134
    v_exp_f32 v135, v135
    ds_read_b128 v[172:175], v16 offset:8448
    ds_read_b128 v[176:179], v16 offset:9216
    v_smfmac_f32_32x32x32_bf16 v[88:103], v[168:171], v[128:135], v1
    v_exp_f32 v136, v136
    v_exp_f32 v137, v137
    v_exp_f32 v138, v138
    v_exp_f32 v139, v139
    v_mfma_f32_32x32x8bf16_1k v[120:135], v[162:163], v[34:35], 0
    v_exp_f32 v140, v140
    v_exp_f32 v141, v141
    v_exp_f32 v142, v142
    v_exp_f32 v143, v143
    v_mfma_f32_32x32x16_bf16 v[120:135], v[158:161], v[30:33], v[120:135]
    v_exp_f32 v144, v144
    v_exp_f32 v145, v145
    v_exp_f32 v146, v146
    v_exp_f32 v147, v147
    v_smfmac_f32_32x32x32_bf16 v[104:119], v[164:167], v[136:143], v1
    v_exp_f32 v148, v148
    v_exp_f32 v149, v149
    v_exp_f32 v150, v150
    v_exp_f32 v151, v151
    s_cmp_eq_u32 s100, 0
    s_cbranch_scc1 concat_heads__sliding_block__grouped_kv_mqa__prompt_kernel_g0
    s_mov_b32 m0, s57
    s_add_u32 s56, s56, 22528
    s_xor_b32 s57, s57, 0x8000
    s_add_u32 s2, s56, 4096
    s_cmp_ge_u32 s94, 6
    s_waitcnt vmcnt(0) lgkmcnt(0)
    s_barrier
    s_cbranch_scc1 concat_heads__sliding_block__grouped_kv_mqa__prompt_kernel_g1w
    buffer_load_dwordx4 v17, s[4:7], s56 offen offset:0 sc1 lds
    buffer_load_dwordx4 v17, s[4:7], s56 offen offset:1024 sc1 lds
    buffer_load_dwordx4 v17, s[4:7], s56 offen offset:2048 sc1 lds
    buffer_load_dwordx4 v17, s[4:7], s56 offen offset:3072 sc1 lds
    s_add_u32 m0, m0, 4096
    s_cmp_lt_u32 s94, 4
    buffer_load_dwordx4 v17, s[4:7], s2 offen offset:0 sc1 lds
    buffer_load_dwordx4 v17, s[4:7], s2 offen offset:1024 sc1 lds
    s_cbranch_scc1 concat_heads__sliding_block__grouped_kv_mqa__prompt_kernel_g1
concat_heads__sliding_block__grouped_kv_mqa__prompt_kernel_qac:
    v_xor_b32 v14, 0x8000, v14
    v_xor_b32 v15, 0x8000, v15
    v_xor_b32 v16, 0x8000, v16
    ds_read_b128 v[152:155], v14 offset:0
    ds_read_b64 v[156:157], v15 offset:0
    v_smfmac_f32_32x32x32_bf16 v[104:119], v[168:171], v[144:151], v1
    v_exp_f32 v120, v120
    v_exp_f32 v121, v121
    v_exp_f32 v122, v122
    v_exp_f32 v123, v123
    v_mfma_f32_32x32x8bf16_1k v[136:151], v[162:163], v[40:41], 0
    v_exp_f32 v124, v124
    v_exp_f32 v125, v125
    v_exp_f32 v126, v126
    v_exp_f32 v127, v127
    v_mfma_f32_32x32x16_bf16 v[136:151], v[158:161], v[36:39], v[136:151]
    v_exp_f32 v128, v128
    v_exp_f32 v129, v129
    v_exp_f32 v130, v130
    v_exp_f32 v131, v131
    s_waitcnt lgkmcnt(0)
    v_smfmac_f32_32x32x32_bf16 v[88:103], v[172:175], v[120:127], v1
    v_exp_f32 v132, v132
    v_exp_f32 v133, v133
    v_exp_f32 v134, v134
    v_exp_f32 v135, v135
    ds_read_b128 v[164:167], v16 offset:0
    ds_read_b128 v[168:171], v16 offset:768
    v_smfmac_f32_32x32x32_bf16 v[88:103], v[176:179], v[128:135], v1
    v_exp_f32 v136, v136
    v_exp_f32 v137, v137
    v_exp_f32 v138, v138
    v_exp_f32 v139, v139
    v_mfma_f32_32x32x8bf16_1k v[120:135], v[156:157], v[34:35], 0
    v_exp_f32 v140, v140
    v_exp_f32 v141, v141
    v_exp_f32 v142, v142
    v_exp_f32 v143, v143
    v_mfma_f32_32x32x16_bf16 v[120:135], v[152:155], v[30:33], v[120:135]
    v_exp_f32 v144, v144
    v_exp_f32 v145, v145
    v_exp_f32 v146, v146
    v_exp_f32 v147, v147
    v_smfmac_f32_32x32x32_bf16 v[104:119], v[172:175], v[136:143], v1
    v_exp_f32 v148, v148
    v_exp_f32 v149, v149
    v_exp_f32 v150, v150
    v_exp_f32 v151, v151
    ds_read_b128 v[158:161], v14 offset:2816
    ds_read_b64 v[162:163], v15 offset:2816
    s_add_u32 s94, s94, 1
    s_cmp_lt_u32 s94, 8
    s_cbranch_scc1 concat_heads__sliding_block__grouped_kv_mqa__prompt_kernel_bloop
    v_smfmac_f32_32x32x32_bf16 v[104:119], v[176:179], v[144:151], v1
    ds_read_b128 v[208:211], v18 offset:19712
    ds_read_b128 v[212:215], v18 offset:22528
    s_mov_b32 exec_hi, 0
    ds_read_b64 v[230:231], v19 offset:20736
    ds_read_b64 v[232:233], v19 offset:23552
    ds_read_b64 v[216:217], v19 offset:1024
    ds_read_b64 v[218:219], v19 offset:3840
    ds_read_b64 v[220:221], v19 offset:6656
    ds_read_b64 v[222:223], v19 offset:9472
    ds_read_b64 v[224:225], v19 offset:12288
    ds_read_b64 v[226:227], v19 offset:15104
    ds_read_b64 v[228:229], v19 offset:17920
    s_mov_b32 exec_hi, -1
    s_xor_b32 s44, s36, 4
    s_cmp_lt_u32 s44, 3
    s_cselect_b32 s3, 0, 2048
    s_mul_i32 s2, s44, 3072
    s_add_u32 s2, s2, s3
    s_add_u32 s2, s2, 2816
    v_add_u32 v8, s2, v2
    s_cmp_lt_u32 s36, 3
    s_cselect_b32 s3, 0, 2048
    s_mul_i32 s2, s36, 3072
    s_add_u32 s2, s2, s3
    s_add_u32 s2, s2, 2816
    v_add_u32 v7, s2, v2
    ds_write_b128 v8, v[104:107] offset:0
    ds_write_b128 v8, v[108:111] offset:1024
    ds_write_b128 v8, v[112:115] offset:2048
    s_waitcnt lgkmcnt(10)
    v_mfma_f32_32x32x8bf16_1k v[120:135], v[230:231], v[28:29], 0
    v_mfma_f32_32x32x16_bf16 v[120:135], v[208:211], v[24:27], v[120:135]
    v_mfma_f32_32x32x8bf16_1k v[136:151], v[232:233], v[28:29], v[44:59]
    v_mfma_f32_32x32x16_bf16 v[136:151], v[212:215], v[24:27], v[136:151]
    ds_read_b128 v[180:183], v18 offset:0
    ds_read_b128 v[184:187], v18 offset:2816
    ds_read_b128 v[188:191], v18 offset:5632
    ds_read_b128 v[192:195], v18 offset:8448
    ds_read_b128 v[196:199], v18 offset:11264
    ds_read_b128 v[200:203], v18 offset:14080
    ds_read_b128 v[204:207], v18 offset:16896
    s_nop 3
    v_max_f32 v10, v120, v121
    v_max_f32 v11, v122, v123
    v_max3_f32 v10, v124, v125, v10
    v_max3_f32 v11, v126, v127, v11
    v_max3_f32 v10, v128, v129, v10
    v_max3_f32 v11, v130, v131, v11
    v_max3_f32 v10, v132, v133, v10
    v_max3_f32 v11, v134, v135, v11
    v_max3_f32 v10, v136, v137, v10
    v_max3_f32 v11, v138, v139, v11
    v_max3_f32 v10, v140, v141, v10
    v_max3_f32 v11, v142, v143, v11
    v_max3_f32 v10, v144, v145, v10
    v_max3_f32 v11, v146, v147, v11
    v_max3_f32 v10, v148, v149, v10
    v_max3_f32 v11, v150, v151, v11
    v_max_f32 v10, v10, v11
    v_mov_b32 v11, v10
    s_mov_b32 s2, 0xffff0000
    s_nop 0
    v_permlane32_swap_b32 v10, v11
    s_nop 1
    v_max_f32 v10, v10, v11
    v_sub_f32 v10, 0xc2700000, v10
    v_and_b32 v11, s2, v10
    v_sub_f32 v10, v10, v11
    v_and_b32 v12, s2, v10
    v_sub_f32 v10, v10, v12
    v_lshrrev_b32 v11, 16, v11
    v_lshrrev_b32 v10, 16, v10
    s_mov_b32 exec_lo, 0
    v_or_b32 v28, v11, v12
    v_or_b32 v29, 0x3f800000, v10
    s_mov_b32 exec_lo, -1
    s_nop 1
    s_waitcnt lgkmcnt(0)
    v_mfma_f32_32x32x8bf16_1k v[120:135], v[216:217], v[28:29], v[60:75]
    v_mfma_f32_32x32x16_bf16 v[120:135], v[180:183], v[24:27], v[120:135]
    s_waitcnt lgkmcnt(0)
    s_barrier
    ds_read_b128 v[104:107], v7 offset:0
    ds_read_b128 v[108:111], v7 offset:1024
    ds_read_b128 v[112:115], v7 offset:2048
    s_mov_b64 exec, s[62:63]
    ds_read_b128 v[164:167], v20 offset:0
    ds_read_b128 v[168:171], v20 offset:768
    s_mov_b64 exec, -1
    s_waitcnt lgkmcnt(2)
    s_cmp_eq_u32 s100, 0
    s_barrier
    s_cbranch_scc1 concat_heads__sliding_block__grouped_kv_mqa__prompt_kernel_nw2
    s_and_b32 s42, s36, 3
    s_mul_i32 s40, s42, 800
    s_add_u32 m0, s40, 0
    s_mul_i32 s41, s42, 6400
    s_mul_i32 s42, s95, 160
    s_add_u32 s41, s41, s42
    s_add_u32 s41, s41, 409600
    s_mov_b32 s42, 8
    s_mov_b64 exec, s[48:49]
concat_heads__sliding_block__grouped_kv_mqa__prompt_kernel_wb2:
    buffer_load_dwordx4 v3, s[24:27], s41 offen lds
    s_add_u32 m0, m0, 3200
    s_add_u32 s41, s41, 25600
    s_sub_u32 s42, s42, 1
    s_cmp_lg_u32 s42, 0
    s_cbranch_scc1 concat_heads__sliding_block__grouped_kv_mqa__prompt_kernel_wb2
    s_mov_b64 exec, -1
concat_heads__sliding_block__grouped_kv_mqa__prompt_kernel_nw2:
    v_add_f32 v88, v88, v104
    v_add_f32 v89, v89, v105
    v_add_f32 v90, v90, v106
    v_add_f32 v91, v91, v107
    v_add_f32 v92, v92, v108
    v_add_f32 v93, v93, v109
    v_add_f32 v94, v94, v110
    v_add_f32 v95, v95, v111
    v_add_f32 v96, v96, v112
    v_add_f32 v97, v97, v113
    v_add_f32 v98, v98, v114
    v_add_f32 v99, v99, v115
concat_heads__sliding_block__grouped_kv_mqa__prompt_kernel_fin:
    v_mov_b32 v10, v96
    v_mov_b32 v11, v96
    s_mov_b32 s2, 0x1f800000
    s_mov_b32 s3, 0x7e800000
    v_permlane32_swap_b32 v10, v11
    s_nop 0
    v_rcp_f32 v10, v11
    v_cmp_gt_f32 s[44:45], s2, v11
    v_cmp_ngt_f32 s[46:47], s3, v11
    v_mov_b32 v11, v10
    v_pk_mul_f32 v[88:89], v[88:89], v[10:11]
    v_pk_mul_f32 v[90:91], v[90:91], v[10:11]
    v_pk_mul_f32 v[92:93], v[92:93], v[10:11]
    v_pk_mul_f32 v[94:95], v[94:95], v[10:11]
    v_pk_mul_f32 v[96:97], v[96:97], v[10:11]
    v_pk_mul_f32 v[98:99], v[98:99], v[10:11]
    v_pk_add_f32 v[10:11], v[88:89], v[90:91]
    v_pk_add_f32 v[100:101], v[92:93], v[94:95]
    v_pk_add_f32 v[102:103], v[96:97], v[98:99]
    s_or_b64 s[44:45], s[44:45], s[46:47]
    v_pk_add_f32 v[10:11], v[10:11], v[100:101]
    v_pk_add_f32 v[10:11], v[10:11], v[102:103]
    v_add_f32 v10, v10, v11
    v_cmp_ngt_f32 vcc, s3, abs(v10)
    s_cmp_eq_u32 s101, 0
    s_cselect_b64 s[2:3], -1, 0
    s_or_b64 vcc, vcc, s[44:45]
    s_and_b64 vcc, vcc, s[2:3]
    s_cbranch_vccnz concat_heads__sliding_block__grouped_kv_mqa__prompt_kernel_slow
    v_cvt_pk_bf16_f32 v88, v88, v89
    v_cvt_pk_bf16_f32 v89, v90, v91
    v_cvt_pk_bf16_f32 v90, v92, v93
    v_cvt_pk_bf16_f32 v91, v94, v95
    v_cvt_pk_bf16_f32 v92, v96, v97
    v_cvt_pk_bf16_f32 v93, v98, v99
    buffer_store_dwordx4 v[88:91], v5, s[20:23], s54 offen sc1
    buffer_store_dwordx2 v[92:93], v6, s[20:23], s55 offen sc1
    s_mov_b32 s101, 0
.p2align 3
    s_branch concat_heads__sliding_block__grouped_kv_mqa__prompt_kernel_ap3
concat_heads__sliding_block__grouped_kv_mqa__prompt_kernel_ap2:
    v_mfma_f32_32x32x8bf16_1k v[120:135], v[216:217], v[28:29], v[60:75]
    v_mfma_f32_32x32x16_bf16 v[120:135], v[180:183], v[24:27], v[120:135]
concat_heads__sliding_block__grouped_kv_mqa__prompt_kernel_ap3:
    v_mov_b32 v104, 0
    v_mov_b32 v105, 0
    v_mov_b32 v106, 0
    v_mov_b32 v107, 0
    v_mov_b32 v108, 0
    v_mov_b32 v109, 0
    v_mov_b32 v110, 0
    v_mov_b32 v111, 0
    v_mov_b32 v112, 0
    v_mov_b32 v113, 0
    v_mov_b32 v114, 0
    v_mov_b32 v115, 0
    v_mov_b32 v116, 0
    v_mov_b32 v117, 0
    v_mov_b32 v118, 0
    v_mov_b32 v119, 0
    v_exp_f32 v120, v120
    v_exp_f32 v121, v121
    v_exp_f32 v122, v122
    v_exp_f32 v123, v123
    v_mfma_f32_32x32x8bf16_1k v[136:151], v[218:219], v[28:29], 0
    v_exp_f32 v124, v124
    v_exp_f32 v125, v125
    v_exp_f32 v126, v126
    v_exp_f32 v127, v127
    v_mfma_f32_32x32x16_bf16 v[136:151], v[184:187], v[24:27], v[136:151]
    v_exp_f32 v128, v128
    v_exp_f32 v129, v129
    v_exp_f32 v130, v130
    v_exp_f32 v131, v131
    s_waitcnt lgkmcnt(0)
    v_smfmac_f32_32x32x32_bf16 v[104:119], v[164:167], v[120:127], v1
    v_exp_f32 v132, v132
    v_exp_f32 v133, v133
    v_exp_f32 v134, v134
    v_exp_f32 v135, v135
    s_mov_b64 exec, s[62:63]
    ds_read_b128 v[172:175], v20 offset:2816
    ds_read_b128 v[176:179], v20 offset:3584
    s_mov_b64 exec, -1
    v_smfmac_f32_32x32x32_bf16 v[104:119], v[168:171], v[128:135], v1
    v_exp_f32 v136, v136
    v_exp_f32 v137, v137
    v_exp_f32 v138, v138
    v_exp_f32 v139, v139
    v_mfma_f32_32x32x8bf16_1k v[120:135], v[220:221], v[28:29], 0
    v_exp_f32 v140, v140
    v_exp_f32 v141, v141
    v_exp_f32 v142, v142
    v_exp_f32 v143, v143
    v_mfma_f32_32x32x16_bf16 v[120:135], v[188:191], v[24:27], v[120:135]
    v_exp_f32 v144, v144
    v_exp_f32 v145, v145
    v_exp_f32 v146, v146
    v_exp_f32 v147, v147
    s_waitcnt lgkmcnt(0)
    v_smfmac_f32_32x32x32_bf16 v[104:119], v[172:175], v[136:143], v1
    v_exp_f32 v148, v148
    v_exp_f32 v149, v149
    v_exp_f32 v150, v150
    v_exp_f32 v151, v151
    s_mov_b64 exec, s[62:63]
    ds_read_b128 v[164:167], v20 offset:5632
    ds_read_b128 v[168:171], v20 offset:6400
    s_mov_b64 exec, -1
    v_smfmac_f32_32x32x32_bf16 v[104:119], v[176:179], v[144:151], v1
    v_exp_f32 v120, v120
    v_exp_f32 v121, v121
    v_exp_f32 v122, v122
    v_exp_f32 v123, v123
    v_mfma_f32_32x32x8bf16_1k v[136:151], v[222:223], v[28:29], 0
    v_exp_f32 v124, v124
    v_exp_f32 v125, v125
    v_exp_f32 v126, v126
    v_exp_f32 v127, v127
    v_mfma_f32_32x32x16_bf16 v[136:151], v[192:195], v[24:27], v[136:151]
    v_exp_f32 v128, v128
    v_exp_f32 v129, v129
    v_exp_f32 v130, v130
    v_exp_f32 v131, v131
    s_waitcnt lgkmcnt(0)
    v_smfmac_f32_32x32x32_bf16 v[104:119], v[164:167], v[120:127], v1
    v_exp_f32 v132, v132
    v_exp_f32 v133, v133
    v_exp_f32 v134, v134
    v_exp_f32 v135, v135
    s_mov_b64 exec, s[62:63]
    ds_read_b128 v[172:175], v20 offset:8448
    ds_read_b128 v[176:179], v20 offset:9216
    s_mov_b64 exec, -1
    v_smfmac_f32_32x32x32_bf16 v[104:119], v[168:171], v[128:135], v1
    v_exp_f32 v136, v136
    v_exp_f32 v137, v137
    v_exp_f32 v138, v138
    v_exp_f32 v139, v139
    v_mfma_f32_32x32x8bf16_1k v[120:135], v[224:225], v[28:29], 0
    v_exp_f32 v140, v140
    v_exp_f32 v141, v141
    v_exp_f32 v142, v142
    v_exp_f32 v143, v143
    v_mfma_f32_32x32x16_bf16 v[120:135], v[196:199], v[24:27], v[120:135]
    v_exp_f32 v144, v144
    v_exp_f32 v145, v145
    v_exp_f32 v146, v146
    v_exp_f32 v147, v147
    s_waitcnt lgkmcnt(0)
    v_smfmac_f32_32x32x32_bf16 v[104:119], v[172:175], v[136:143], v1
    v_exp_f32 v148, v148
    v_exp_f32 v149, v149
    v_exp_f32 v150, v150
    v_exp_f32 v151, v151
    s_mov_b64 exec, s[62:63]
    ds_read_b128 v[164:167], v20 offset:11264
    ds_read_b128 v[168:171], v20 offset:12032
    s_mov_b64 exec, -1
    v_smfmac_f32_32x32x32_bf16 v[104:119], v[176:179], v[144:151], v1
    v_exp_f32 v120, v120
    v_exp_f32 v121, v121
    v_exp_f32 v122, v122
    v_exp_f32 v123, v123
    v_mfma_f32_32x32x8bf16_1k v[136:151], v[226:227], v[28:29], 0
    v_exp_f32 v124, v124
    v_exp_f32 v125, v125
    v_exp_f32 v126, v126
    v_exp_f32 v127, v127
    v_mfma_f32_32x32x16_bf16 v[136:151], v[200:203], v[24:27], v[136:151]
    v_exp_f32 v128, v128
    v_exp_f32 v129, v129
    v_exp_f32 v130, v130
    v_exp_f32 v131, v131
    s_waitcnt lgkmcnt(0)
    v_smfmac_f32_32x32x32_bf16 v[104:119], v[164:167], v[120:127], v1
    v_exp_f32 v132, v132
    v_exp_f32 v133, v133
    v_exp_f32 v134, v134
    v_exp_f32 v135, v135
    s_mov_b64 exec, s[62:63]
    ds_read_b128 v[172:175], v20 offset:14080
    ds_read_b128 v[176:179], v20 offset:14848
    s_mov_b64 exec, -1
    v_smfmac_f32_32x32x32_bf16 v[104:119], v[168:171], v[128:135], v1
    v_exp_f32 v136, v136
    v_exp_f32 v137, v137
    v_exp_f32 v138, v138
    v_exp_f32 v139, v139
    v_mfma_f32_32x32x8bf16_1k v[120:135], v[228:229], v[28:29], 0
    v_exp_f32 v140, v140
    v_exp_f32 v141, v141
    v_exp_f32 v142, v142
    v_exp_f32 v143, v143
    v_mfma_f32_32x32x16_bf16 v[120:135], v[204:207], v[24:27], v[120:135]
    v_exp_f32 v144, v144
    v_exp_f32 v145, v145
    v_exp_f32 v146, v146
    v_exp_f32 v147, v147
    s_waitcnt lgkmcnt(0)
    v_smfmac_f32_32x32x32_bf16 v[104:119], v[172:175], v[136:143], v1
    v_exp_f32 v148, v148
    v_exp_f32 v149, v149
    v_exp_f32 v150, v150
    v_exp_f32 v151, v151
    s_mov_b64 exec, s[62:63]
    ds_read_b128 v[164:167], v20 offset:16896
    ds_read_b128 v[168:171], v20 offset:17664
    s_mov_b64 exec, -1
    v_smfmac_f32_32x32x32_bf16 v[104:119], v[176:179], v[144:151], v1
    v_exp_f32 v120, v120
    v_exp_f32 v121, v121
    v_exp_f32 v122, v122
    v_exp_f32 v123, v123
    v_mfma_f32_32x32x8bf16_1k v[136:151], v[230:231], v[28:29], 0
    v_exp_f32 v124, v124
    v_exp_f32 v125, v125
    v_exp_f32 v126, v126
    v_exp_f32 v127, v127
    v_mfma_f32_32x32x16_bf16 v[136:151], v[208:211], v[24:27], v[136:151]
    v_exp_f32 v128, v128
    v_exp_f32 v129, v129
    v_exp_f32 v130, v130
    v_exp_f32 v131, v131
    s_waitcnt lgkmcnt(0)
    v_smfmac_f32_32x32x32_bf16 v[104:119], v[164:167], v[120:127], v1
    v_exp_f32 v132, v132
    v_exp_f32 v133, v133
    v_exp_f32 v134, v134
    v_exp_f32 v135, v135
    s_mov_b64 exec, s[62:63]
    ds_read_b128 v[172:175], v20 offset:19712
    ds_read_b128 v[176:179], v20 offset:20480
    s_mov_b64 exec, -1
    v_smfmac_f32_32x32x32_bf16 v[104:119], v[168:171], v[128:135], v1
    v_exp_f32 v136, v136
    v_exp_f32 v137, v137
    v_exp_f32 v138, v138
    v_exp_f32 v139, v139
    v_mfma_f32_32x32x8bf16_1k v[120:135], v[232:233], v[28:29], v[44:59]
    v_exp_f32 v140, v140
    v_exp_f32 v141, v141
    v_exp_f32 v142, v142
    v_exp_f32 v143, v143
    v_mfma_f32_32x32x16_bf16 v[120:135], v[212:215], v[24:27], v[120:135]
    v_exp_f32 v144, v144
    v_exp_f32 v145, v145
    v_exp_f32 v146, v146
    v_exp_f32 v147, v147
    s_waitcnt lgkmcnt(0)
    v_smfmac_f32_32x32x32_bf16 v[104:119], v[172:175], v[136:143], v1
    v_exp_f32 v148, v148
    v_exp_f32 v149, v149
    v_exp_f32 v150, v150
    v_exp_f32 v151, v151
    s_mov_b64 exec, s[62:63]
    ds_read_b128 v[164:167], v20 offset:22528
    ds_read_b128 v[168:171], v20 offset:23296
    s_mov_b64 exec, -1
    v_smfmac_f32_32x32x32_bf16 v[104:119], v[176:179], v[144:151], v1
    v_exp_f32 v120, v120
    v_exp_f32 v121, v121
    v_exp_f32 v122, v122
    v_exp_f32 v123, v123
    v_exp_f32 v124, v124
    v_exp_f32 v125, v125
    v_exp_f32 v126, v126
    v_exp_f32 v127, v127
    v_exp_f32 v128, v128
    v_exp_f32 v129, v129
    v_exp_f32 v130, v130
    v_exp_f32 v131, v131
    s_waitcnt lgkmcnt(0)
    v_smfmac_f32_32x32x32_bf16 v[104:119], v[164:167], v[120:127], v1
    v_exp_f32 v132, v132
    v_exp_f32 v133, v133
    v_exp_f32 v134, v134
    v_exp_f32 v135, v135
    s_nop 1
    v_smfmac_f32_32x32x32_bf16 v[104:119], v[168:171], v[128:135], v1
    s_nop 7
    s_nop 3
    v_mov_b32 v10, v112
    v_mov_b32 v11, v112
    s_mov_b32 s2, 0x1f800000
    s_mov_b32 s3, 0x7e800000
    v_permlane32_swap_b32 v10, v11
    s_nop 0
    v_rcp_f32 v10, v11
    v_cmp_gt_f32 s[44:45], s2, v11
    v_cmp_ngt_f32 s[46:47], s3, v11
    v_mov_b32 v11, v10
    v_pk_mul_f32 v[104:105], v[104:105], v[10:11]
    v_pk_mul_f32 v[106:107], v[106:107], v[10:11]
    v_pk_mul_f32 v[108:109], v[108:109], v[10:11]
    v_pk_mul_f32 v[110:111], v[110:111], v[10:11]
    v_pk_mul_f32 v[112:113], v[112:113], v[10:11]
    v_pk_mul_f32 v[114:115], v[114:115], v[10:11]
    v_pk_add_f32 v[10:11], v[104:105], v[106:107]
    v_pk_add_f32 v[116:117], v[108:109], v[110:111]
    v_pk_add_f32 v[118:119], v[112:113], v[114:115]
    s_or_b64 s[44:45], s[44:45], s[46:47]
    v_pk_add_f32 v[10:11], v[10:11], v[116:117]
    v_pk_add_f32 v[10:11], v[10:11], v[118:119]
    v_add_f32 v10, v10, v11
    v_cmp_ngt_f32 vcc, s3, abs(v10)
    s_cmp_eq_u32 s101, 0
    s_cselect_b64 s[2:3], -1, 0
    s_or_b64 vcc, vcc, s[44:45]
    s_and_b64 vcc, vcc, s[2:3]
    s_cbranch_vccnz concat_heads__sliding_block__grouped_kv_mqa__prompt_kernel_slowa
    v_cvt_pk_bf16_f32 v104, v104, v105
    v_cvt_pk_bf16_f32 v105, v106, v107
    v_cvt_pk_bf16_f32 v106, v108, v109
    v_cvt_pk_bf16_f32 v107, v110, v111
    v_cvt_pk_bf16_f32 v108, v112, v113
    v_cvt_pk_bf16_f32 v109, v114, v115
    buffer_store_dwordx4 v[104:107], v5, s[20:23], s52 offen sc1
    buffer_store_dwordx2 v[108:109], v6, s[20:23], s53 offen sc1
    s_waitcnt vmcnt(0)
    v_mov_b32 v6, 163328
    v_mov_b32 v7, 1
    s_mov_b64 exec, 1
    ds_add_rtn_u32 v7, v6, v7
    s_waitcnt lgkmcnt(0)
    v_readfirstlane_b32 s2, v7
    v_mov_b32 v7, 3
    s_cmp_eq_u32 s2, 7
    s_cbranch_scc0 concat_heads__sliding_block__grouped_kv_mqa__prompt_kernel_ar
    buffer_store_dword v7, off, s[20:23], s93 sc1
concat_heads__sliding_block__grouped_kv_mqa__prompt_kernel_ar:
    s_mov_b64 exec, -1
    s_cmp_ge_u32 s36, 4
    s_cbranch_scc0 concat_heads__sliding_block__grouped_kv_mqa__prompt_kernel_p3
    s_barrier
    s_endpgm
.p2align 3
concat_heads__sliding_block__grouped_kv_mqa__prompt_kernel_p3:
    buffer_load_dword v5, v254, s[20:23], 0 offen sc1
    s_lshl_b32 s40, s92, 2
    s_lshr_b32 s42, s37, 6
    s_add_u32 s40, s40, s42
    s_bitcmp1_b32 s37, 0
    s_cselect_b32 s44, 3, 3
    s_cselect_b32 s45, 2621440, 0
    s_lshl_b32 s41, s40, 2
    s_add_u32 s41, s41, s36
    s_mul_i32 s46, s41, 40960
    s_add_u32 s46, s46, s45
    s_add_u32 s46, s46, 8572928
    s_add_u32 s47, s46, 20480
    s_add_u32 s48, s46, 16384
    s_add_u32 s49, s47, 16384
    s_barrier
    ds_read_b64_tr_b16 v[48:49], v252 offset:0
    ds_read_b64_tr_b16 v[50:51], v252 offset:1280
    ds_read_b64_tr_b16 v[52:53], v252 offset:32
    ds_read_b64_tr_b16 v[54:55], v252 offset:1312
    ds_read_b64_tr_b16 v[56:57], v252 offset:64
    ds_read_b64_tr_b16 v[58:59], v252 offset:1344
    ds_read_b64_tr_b16 v[60:61], v252 offset:96
    ds_read_b64_tr_b16 v[62:63], v252 offset:1376
    ds_read_b64_tr_b16 v[64:65], v252 offset:128
    ds_read_b64_tr_b16 v[66:67], v252 offset:1408
    s_waitcnt vmcnt(0)
    s_mov_b32 s3, 0
concat_heads__sliding_block__grouped_kv_mqa__prompt_kernel_spo:
    v_cmp_gt_u32 vcc, s44, v5
    s_add_u32 s3, s3, 1
    s_cbranch_vccz concat_heads__sliding_block__grouped_kv_mqa__prompt_kernel_sdo
    s_cmp_gt_u32 s3, 400000
    s_cbranch_scc1 concat_heads__sliding_block__grouped_kv_mqa__prompt_kernel_sdo
    buffer_load_dword v5, v254, s[20:23], 0 offen sc1
    s_waitcnt vmcnt(0)
    s_branch concat_heads__sliding_block__grouped_kv_mqa__prompt_kernel_spo
concat_heads__sliding_block__grouped_kv_mqa__prompt_kernel_sdo:
    buffer_load_dwordx4 v[88:91], v2, s[20:23], s46 offen offset:0 sc1
    buffer_load_dwordx4 v[92:95], v2, s[20:23], s47 offen offset:0 sc1
    buffer_load_dwordx4 v[96:99], v2, s[20:23], s46 offen offset:1024 sc1
    buffer_load_dwordx4 v[100:103], v2, s[20:23], s47 offen offset:1024 sc1
    buffer_load_dwordx4 v[104:107], v2, s[20:23], s46 offen offset:2048 sc1
    buffer_load_dwordx4 v[108:111], v2, s[20:23], s47 offen offset:2048 sc1
    buffer_load_dwordx4 v[112:115], v2, s[20:23], s46 offen offset:3072 sc1
    buffer_load_dwordx4 v[116:119], v2, s[20:23], s47 offen offset:3072 sc1
    buffer_load_dwordx2 v[120:121], v255, s[20:23], s48 offen offset:0 sc1
    buffer_load_dwordx2 v[122:123], v255, s[20:23], s48 offen offset:128 sc1
    buffer_load_dwordx2 v[124:125], v255, s[20:23], s49 offen offset:0 sc1
    buffer_load_dwordx2 v[126:127], v255, s[20:23], s49 offen offset:128 sc1
    s_add_u32 s46, s46, 0x1000
    s_add_u32 s47, s47, 0x1000
    buffer_load_dwordx4 v[128:131], v2, s[20:23], s46 offen offset:0 sc1
    buffer_load_dwordx4 v[132:135], v2, s[20:23], s47 offen offset:0 sc1
    s_waitcnt vmcnt(12) lgkmcnt(0)
    v_mfma_f32_16x16x32_bf16 v[8:11], v[48:51], v[88:91], 0
    ds_read_b64_tr_b16 v[68:69], v252 offset:6400
    ds_read_b64_tr_b16 v[70:71], v252 offset:7680
    v_mfma_f32_16x16x32_bf16 v[28:31], v[48:51], v[92:95], 0
    ds_read_b64_tr_b16 v[72:73], v252 offset:6432
    ds_read_b64_tr_b16 v[74:75], v252 offset:7712
    v_mfma_f32_16x16x32_bf16 v[12:15], v[52:55], v[88:91], 0
    ds_read_b64_tr_b16 v[76:77], v252 offset:6464
    ds_read_b64_tr_b16 v[78:79], v252 offset:7744
    v_mfma_f32_16x16x32_bf16 v[32:35], v[52:55], v[92:95], 0
    ds_read_b64_tr_b16 v[80:81], v252 offset:6496
    ds_read_b64_tr_b16 v[82:83], v252 offset:7776
    v_mfma_f32_16x16x32_bf16 v[16:19], v[56:59], v[88:91], 0
    ds_read_b64_tr_b16 v[84:85], v252 offset:6528
    ds_read_b64_tr_b16 v[86:87], v252 offset:7808
    v_mfma_f32_16x16x32_bf16 v[36:39], v[56:59], v[92:95], 0
    buffer_load_dwordx4 v[136:139], v2, s[20:23], s46 offen offset:1024 sc1
    v_mfma_f32_16x16x32_bf16 v[20:23], v[60:63], v[88:91], 0
    v_mfma_f32_16x16x32_bf16 v[40:43], v[60:63], v[92:95], 0
    buffer_load_dwordx4 v[140:143], v2, s[20:23], s47 offen offset:1024 sc1
    v_mfma_f32_16x16x32_bf16 v[24:27], v[64:67], v[88:91], 0
    v_mfma_f32_16x16x32_bf16 v[44:47], v[64:67], v[92:95], 0
    s_waitcnt vmcnt(12) lgkmcnt(0)
    v_mfma_f32_16x16x32_bf16 v[8:11], v[68:71], v[96:99], v[8:11]
    ds_read_b64_tr_b16 v[48:49], v252 offset:12800
    ds_read_b64_tr_b16 v[50:51], v252 offset:14080
    v_mfma_f32_16x16x32_bf16 v[28:31], v[68:71], v[100:103], v[28:31]
    ds_read_b64_tr_b16 v[52:53], v252 offset:12832
    ds_read_b64_tr_b16 v[54:55], v252 offset:14112
    v_mfma_f32_16x16x32_bf16 v[12:15], v[72:75], v[96:99], v[12:15]
    ds_read_b64_tr_b16 v[56:57], v252 offset:12864
    ds_read_b64_tr_b16 v[58:59], v252 offset:14144
    v_mfma_f32_16x16x32_bf16 v[32:35], v[72:75], v[100:103], v[32:35]
    ds_read_b64_tr_b16 v[60:61], v252 offset:12896
    ds_read_b64_tr_b16 v[62:63], v252 offset:14176
    v_mfma_f32_16x16x32_bf16 v[16:19], v[76:79], v[96:99], v[16:19]
    ds_read_b64_tr_b16 v[64:65], v252 offset:12928
    ds_read_b64_tr_b16 v[66:67], v252 offset:14208
    v_mfma_f32_16x16x32_bf16 v[36:39], v[76:79], v[100:103], v[36:39]
    buffer_load_dwordx4 v[144:147], v2, s[20:23], s46 offen offset:2048 sc1
    v_mfma_f32_16x16x32_bf16 v[20:23], v[80:83], v[96:99], v[20:23]
    v_mfma_f32_16x16x32_bf16 v[40:43], v[80:83], v[100:103], v[40:43]
    buffer_load_dwordx4 v[148:151], v2, s[20:23], s47 offen offset:2048 sc1
    v_mfma_f32_16x16x32_bf16 v[24:27], v[84:87], v[96:99], v[24:27]
    v_mfma_f32_16x16x32_bf16 v[44:47], v[84:87], v[100:103], v[44:47]
    s_waitcnt vmcnt(12) lgkmcnt(0)
    v_mfma_f32_16x16x32_bf16 v[8:11], v[48:51], v[104:107], v[8:11]
    ds_read_b64_tr_b16 v[68:69], v252 offset:19200
    ds_read_b64_tr_b16 v[70:71], v252 offset:20480
    v_mfma_f32_16x16x32_bf16 v[28:31], v[48:51], v[108:111], v[28:31]
    ds_read_b64_tr_b16 v[72:73], v252 offset:19232
    ds_read_b64_tr_b16 v[74:75], v252 offset:20512
    v_mfma_f32_16x16x32_bf16 v[12:15], v[52:55], v[104:107], v[12:15]
    ds_read_b64_tr_b16 v[76:77], v252 offset:19264
    ds_read_b64_tr_b16 v[78:79], v252 offset:20544
    v_mfma_f32_16x16x32_bf16 v[32:35], v[52:55], v[108:111], v[32:35]
    ds_read_b64_tr_b16 v[80:81], v252 offset:19296
    ds_read_b64_tr_b16 v[82:83], v252 offset:20576
    v_mfma_f32_16x16x32_bf16 v[16:19], v[56:59], v[104:107], v[16:19]
    ds_read_b64_tr_b16 v[84:85], v252 offset:19328
    ds_read_b64_tr_b16 v[86:87], v252 offset:20608
    v_mfma_f32_16x16x32_bf16 v[36:39], v[56:59], v[108:111], v[36:39]
    buffer_load_dwordx4 v[152:155], v2, s[20:23], s46 offen offset:3072 sc1
    v_mfma_f32_16x16x32_bf16 v[20:23], v[60:63], v[104:107], v[20:23]
    v_mfma_f32_16x16x32_bf16 v[40:43], v[60:63], v[108:111], v[40:43]
    buffer_load_dwordx4 v[156:159], v2, s[20:23], s47 offen offset:3072 sc1
    v_mfma_f32_16x16x32_bf16 v[24:27], v[64:67], v[104:107], v[24:27]
    v_mfma_f32_16x16x32_bf16 v[44:47], v[64:67], v[108:111], v[44:47]
    s_waitcnt vmcnt(12) lgkmcnt(0)
    v_mfma_f32_16x16x32_bf16 v[8:11], v[68:71], v[112:115], v[8:11]
    ds_read_b64_tr_b16 v[48:49], v253 offset:0
    ds_read_b64_tr_b16 v[50:51], v253 offset:3200
    v_mfma_f32_16x16x32_bf16 v[28:31], v[68:71], v[116:119], v[28:31]
    ds_read_b64_tr_b16 v[52:53], v253 offset:32
    ds_read_b64_tr_b16 v[54:55], v253 offset:3232
    v_mfma_f32_16x16x32_bf16 v[12:15], v[72:75], v[112:115], v[12:15]
    ds_read_b64_tr_b16 v[56:57], v253 offset:64
    ds_read_b64_tr_b16 v[58:59], v253 offset:3264
    v_mfma_f32_16x16x32_bf16 v[32:35], v[72:75], v[116:119], v[32:35]
    ds_read_b64_tr_b16 v[60:61], v253 offset:96
    ds_read_b64_tr_b16 v[62:63], v253 offset:3296
    v_mfma_f32_16x16x32_bf16 v[16:19], v[76:79], v[112:115], v[16:19]
    ds_read_b64_tr_b16 v[64:65], v253 offset:128
    ds_read_b64_tr_b16 v[66:67], v253 offset:3328
    v_mfma_f32_16x16x32_bf16 v[36:39], v[76:79], v[116:119], v[36:39]
    buffer_load_dwordx2 v[160:161], v255, s[20:23], s48 offen offset:1024 sc1
    buffer_load_dwordx2 v[162:163], v255, s[20:23], s48 offen offset:1152 sc1
    buffer_load_dwordx2 v[164:165], v255, s[20:23], s49 offen offset:1024 sc1
    v_mfma_f32_16x16x32_bf16 v[20:23], v[80:83], v[112:115], v[20:23]
    v_mfma_f32_16x16x32_bf16 v[40:43], v[80:83], v[116:119], v[40:43]
    buffer_load_dwordx2 v[166:167], v255, s[20:23], s49 offen offset:1152 sc1
    v_mfma_f32_16x16x32_bf16 v[24:27], v[84:87], v[112:115], v[24:27]
    v_mfma_f32_16x16x32_bf16 v[44:47], v[84:87], v[116:119], v[44:47]
    s_waitcnt vmcnt(12) lgkmcnt(0)
    v_add_u32 v252, 0x6400, v252
    v_add_u32 v253, 0x6400, v253
    v_mfma_f32_16x16x32_bf16 v[8:11], v[48:51], v[120:123], v[8:11]
    ds_read_b64_tr_b16 v[68:69], v252 offset:0
    ds_read_b64_tr_b16 v[70:71], v252 offset:1280
    v_mfma_f32_16x16x32_bf16 v[28:31], v[48:51], v[124:127], v[28:31]
    ds_read_b64_tr_b16 v[72:73], v252 offset:32
    ds_read_b64_tr_b16 v[74:75], v252 offset:1312
    v_mfma_f32_16x16x32_bf16 v[12:15], v[52:55], v[120:123], v[12:15]
    ds_read_b64_tr_b16 v[76:77], v252 offset:64
    ds_read_b64_tr_b16 v[78:79], v252 offset:1344
    v_mfma_f32_16x16x32_bf16 v[32:35], v[52:55], v[124:127], v[32:35]
    ds_read_b64_tr_b16 v[80:81], v252 offset:96
    ds_read_b64_tr_b16 v[82:83], v252 offset:1376
    v_mfma_f32_16x16x32_bf16 v[16:19], v[56:59], v[120:123], v[16:19]
    ds_read_b64_tr_b16 v[84:85], v252 offset:128
    ds_read_b64_tr_b16 v[86:87], v252 offset:1408
    v_mfma_f32_16x16x32_bf16 v[36:39], v[56:59], v[124:127], v[36:39]
    s_add_u32 s46, s46, 0x1000
    s_add_u32 s47, s47, 0x1000
    buffer_load_dwordx4 v[168:171], v2, s[20:23], s46 offen offset:0 sc1
    v_mfma_f32_16x16x32_bf16 v[20:23], v[60:63], v[120:123], v[20:23]
    v_mfma_f32_16x16x32_bf16 v[40:43], v[60:63], v[124:127], v[40:43]
    buffer_load_dwordx4 v[172:175], v2, s[20:23], s47 offen offset:0 sc1
    v_mfma_f32_16x16x32_bf16 v[24:27], v[64:67], v[120:123], v[24:27]
    v_mfma_f32_16x16x32_bf16 v[44:47], v[64:67], v[124:127], v[44:47]
    s_waitcnt vmcnt(12) lgkmcnt(0)
    v_mfma_f32_16x16x32_bf16 v[8:11], v[68:71], v[128:131], v[8:11]
    ds_read_b64_tr_b16 v[48:49], v252 offset:6400
    ds_read_b64_tr_b16 v[50:51], v252 offset:7680
    v_mfma_f32_16x16x32_bf16 v[28:31], v[68:71], v[132:135], v[28:31]
    ds_read_b64_tr_b16 v[52:53], v252 offset:6432
    ds_read_b64_tr_b16 v[54:55], v252 offset:7712
    v_mfma_f32_16x16x32_bf16 v[12:15], v[72:75], v[128:131], v[12:15]
    ds_read_b64_tr_b16 v[56:57], v252 offset:6464
    ds_read_b64_tr_b16 v[58:59], v252 offset:7744
    v_mfma_f32_16x16x32_bf16 v[32:35], v[72:75], v[132:135], v[32:35]
    ds_read_b64_tr_b16 v[60:61], v252 offset:6496
    ds_read_b64_tr_b16 v[62:63], v252 offset:7776
    v_mfma_f32_16x16x32_bf16 v[16:19], v[76:79], v[128:131], v[16:19]
    ds_read_b64_tr_b16 v[64:65], v252 offset:6528
    ds_read_b64_tr_b16 v[66:67], v252 offset:7808
    v_mfma_f32_16x16x32_bf16 v[36:39], v[76:79], v[132:135], v[36:39]
    buffer_load_dwordx4 v[176:179], v2, s[20:23], s46 offen offset:1024 sc1
    v_mfma_f32_16x16x32_bf16 v[20:23], v[80:83], v[128:131], v[20:23]
    v_mfma_f32_16x16x32_bf16 v[40:43], v[80:83], v[132:135], v[40:43]
    buffer_load_dwordx4 v[180:183], v2, s[20:23], s47 offen offset:1024 sc1
    v_mfma_f32_16x16x32_bf16 v[24:27], v[84:87], v[128:131], v[24:27]
    v_mfma_f32_16x16x32_bf16 v[44:47], v[84:87], v[132:135], v[44:47]
    s_waitcnt vmcnt(12) lgkmcnt(0)
    v_mfma_f32_16x16x32_bf16 v[8:11], v[48:51], v[136:139], v[8:11]
    ds_read_b64_tr_b16 v[68:69], v252 offset:12800
    ds_read_b64_tr_b16 v[70:71], v252 offset:14080
    v_mfma_f32_16x16x32_bf16 v[28:31], v[48:51], v[140:143], v[28:31]
    ds_read_b64_tr_b16 v[72:73], v252 offset:12832
    ds_read_b64_tr_b16 v[74:75], v252 offset:14112
    v_mfma_f32_16x16x32_bf16 v[12:15], v[52:55], v[136:139], v[12:15]
    ds_read_b64_tr_b16 v[76:77], v252 offset:12864
    ds_read_b64_tr_b16 v[78:79], v252 offset:14144
    v_mfma_f32_16x16x32_bf16 v[32:35], v[52:55], v[140:143], v[32:35]
    ds_read_b64_tr_b16 v[80:81], v252 offset:12896
    ds_read_b64_tr_b16 v[82:83], v252 offset:14176
    v_mfma_f32_16x16x32_bf16 v[16:19], v[56:59], v[136:139], v[16:19]
    ds_read_b64_tr_b16 v[84:85], v252 offset:12928
    ds_read_b64_tr_b16 v[86:87], v252 offset:14208
    v_mfma_f32_16x16x32_bf16 v[36:39], v[56:59], v[140:143], v[36:39]
    buffer_load_dwordx4 v[184:187], v2, s[20:23], s46 offen offset:2048 sc1
    v_mfma_f32_16x16x32_bf16 v[20:23], v[60:63], v[136:139], v[20:23]
    v_mfma_f32_16x16x32_bf16 v[40:43], v[60:63], v[140:143], v[40:43]
    buffer_load_dwordx4 v[188:191], v2, s[20:23], s47 offen offset:2048 sc1
    v_mfma_f32_16x16x32_bf16 v[24:27], v[64:67], v[136:139], v[24:27]
    v_mfma_f32_16x16x32_bf16 v[44:47], v[64:67], v[140:143], v[44:47]
    s_waitcnt vmcnt(12) lgkmcnt(0)
    v_mfma_f32_16x16x32_bf16 v[8:11], v[68:71], v[144:147], v[8:11]
    ds_read_b64_tr_b16 v[48:49], v252 offset:19200
    ds_read_b64_tr_b16 v[50:51], v252 offset:20480
    v_mfma_f32_16x16x32_bf16 v[28:31], v[68:71], v[148:151], v[28:31]
    ds_read_b64_tr_b16 v[52:53], v252 offset:19232
    ds_read_b64_tr_b16 v[54:55], v252 offset:20512
    v_mfma_f32_16x16x32_bf16 v[12:15], v[72:75], v[144:147], v[12:15]
    ds_read_b64_tr_b16 v[56:57], v252 offset:19264
    ds_read_b64_tr_b16 v[58:59], v252 offset:20544
    v_mfma_f32_16x16x32_bf16 v[32:35], v[72:75], v[148:151], v[32:35]
    ds_read_b64_tr_b16 v[60:61], v252 offset:19296
    ds_read_b64_tr_b16 v[62:63], v252 offset:20576
    v_mfma_f32_16x16x32_bf16 v[16:19], v[76:79], v[144:147], v[16:19]
    ds_read_b64_tr_b16 v[64:65], v252 offset:19328
    ds_read_b64_tr_b16 v[66:67], v252 offset:20608
    v_mfma_f32_16x16x32_bf16 v[36:39], v[76:79], v[148:151], v[36:39]
    buffer_load_dwordx4 v[192:195], v2, s[20:23], s46 offen offset:3072 sc1
    v_mfma_f32_16x16x32_bf16 v[20:23], v[80:83], v[144:147], v[20:23]
    v_mfma_f32_16x16x32_bf16 v[40:43], v[80:83], v[148:151], v[40:43]
    buffer_load_dwordx4 v[196:199], v2, s[20:23], s47 offen offset:3072 sc1
    v_mfma_f32_16x16x32_bf16 v[24:27], v[84:87], v[144:147], v[24:27]
    v_mfma_f32_16x16x32_bf16 v[44:47], v[84:87], v[148:151], v[44:47]
    s_waitcnt vmcnt(12) lgkmcnt(0)
    v_mfma_f32_16x16x32_bf16 v[8:11], v[48:51], v[152:155], v[8:11]
    ds_read_b64_tr_b16 v[68:69], v253 offset:0
    ds_read_b64_tr_b16 v[70:71], v253 offset:3200
    v_mfma_f32_16x16x32_bf16 v[28:31], v[48:51], v[156:159], v[28:31]
    ds_read_b64_tr_b16 v[72:73], v253 offset:32
    ds_read_b64_tr_b16 v[74:75], v253 offset:3232
    v_mfma_f32_16x16x32_bf16 v[12:15], v[52:55], v[152:155], v[12:15]
    ds_read_b64_tr_b16 v[76:77], v253 offset:64
    ds_read_b64_tr_b16 v[78:79], v253 offset:3264
    v_mfma_f32_16x16x32_bf16 v[32:35], v[52:55], v[156:159], v[32:35]
    ds_read_b64_tr_b16 v[80:81], v253 offset:96
    ds_read_b64_tr_b16 v[82:83], v253 offset:3296
    v_mfma_f32_16x16x32_bf16 v[16:19], v[56:59], v[152:155], v[16:19]
    ds_read_b64_tr_b16 v[84:85], v253 offset:128
    ds_read_b64_tr_b16 v[86:87], v253 offset:3328
    v_mfma_f32_16x16x32_bf16 v[36:39], v[56:59], v[156:159], v[36:39]
    buffer_load_dwordx2 v[200:201], v255, s[20:23], s48 offen offset:2048 sc1
    buffer_load_dwordx2 v[202:203], v255, s[20:23], s48 offen offset:2176 sc1
    buffer_load_dwordx2 v[204:205], v255, s[20:23], s49 offen offset:2048 sc1
    v_mfma_f32_16x16x32_bf16 v[20:23], v[60:63], v[152:155], v[20:23]
    v_mfma_f32_16x16x32_bf16 v[40:43], v[60:63], v[156:159], v[40:43]
    buffer_load_dwordx2 v[206:207], v255, s[20:23], s49 offen offset:2176 sc1
    v_mfma_f32_16x16x32_bf16 v[24:27], v[64:67], v[152:155], v[24:27]
    v_mfma_f32_16x16x32_bf16 v[44:47], v[64:67], v[156:159], v[44:47]
    s_waitcnt vmcnt(12) lgkmcnt(0)
    v_add_u32 v252, 0xfffdf800, v252
    v_add_u32 v253, 0xfffdf800, v253
    v_mfma_f32_16x16x32_bf16 v[8:11], v[68:71], v[160:163], v[8:11]
    ds_read_b64_tr_b16 v[48:49], v252 offset:0
    ds_read_b64_tr_b16 v[50:51], v252 offset:1280
    v_mfma_f32_16x16x32_bf16 v[28:31], v[68:71], v[164:167], v[28:31]
    ds_read_b64_tr_b16 v[52:53], v252 offset:32
    ds_read_b64_tr_b16 v[54:55], v252 offset:1312
    v_mfma_f32_16x16x32_bf16 v[12:15], v[72:75], v[160:163], v[12:15]
    ds_read_b64_tr_b16 v[56:57], v252 offset:64
    ds_read_b64_tr_b16 v[58:59], v252 offset:1344
    v_mfma_f32_16x16x32_bf16 v[32:35], v[72:75], v[164:167], v[32:35]
    ds_read_b64_tr_b16 v[60:61], v252 offset:96
    ds_read_b64_tr_b16 v[62:63], v252 offset:1376
    v_mfma_f32_16x16x32_bf16 v[16:19], v[76:79], v[160:163], v[16:19]
    ds_read_b64_tr_b16 v[64:65], v252 offset:128
    ds_read_b64_tr_b16 v[66:67], v252 offset:1408
    v_mfma_f32_16x16x32_bf16 v[36:39], v[76:79], v[164:167], v[36:39]
    s_add_u32 s46, s46, 0x1000
    s_add_u32 s47, s47, 0x1000
    buffer_load_dwordx4 v[208:211], v2, s[20:23], s46 offen offset:0 sc1
    v_mfma_f32_16x16x32_bf16 v[20:23], v[80:83], v[160:163], v[20:23]
    v_mfma_f32_16x16x32_bf16 v[40:43], v[80:83], v[164:167], v[40:43]
    buffer_load_dwordx4 v[212:215], v2, s[20:23], s47 offen offset:0 sc1
    v_mfma_f32_16x16x32_bf16 v[24:27], v[84:87], v[160:163], v[24:27]
    v_mfma_f32_16x16x32_bf16 v[44:47], v[84:87], v[164:167], v[44:47]
    s_waitcnt vmcnt(12) lgkmcnt(0)
    v_mfma_f32_16x16x32_bf16 v[8:11], v[48:51], v[168:171], v[8:11]
    ds_read_b64_tr_b16 v[68:69], v252 offset:6400
    ds_read_b64_tr_b16 v[70:71], v252 offset:7680
    v_mfma_f32_16x16x32_bf16 v[28:31], v[48:51], v[172:175], v[28:31]
    ds_read_b64_tr_b16 v[72:73], v252 offset:6432
    ds_read_b64_tr_b16 v[74:75], v252 offset:7712
    v_mfma_f32_16x16x32_bf16 v[12:15], v[52:55], v[168:171], v[12:15]
    ds_read_b64_tr_b16 v[76:77], v252 offset:6464
    ds_read_b64_tr_b16 v[78:79], v252 offset:7744
    v_mfma_f32_16x16x32_bf16 v[32:35], v[52:55], v[172:175], v[32:35]
    ds_read_b64_tr_b16 v[80:81], v252 offset:6496
    ds_read_b64_tr_b16 v[82:83], v252 offset:7776
    v_mfma_f32_16x16x32_bf16 v[16:19], v[56:59], v[168:171], v[16:19]
    ds_read_b64_tr_b16 v[84:85], v252 offset:6528
    ds_read_b64_tr_b16 v[86:87], v252 offset:7808
    v_mfma_f32_16x16x32_bf16 v[36:39], v[56:59], v[172:175], v[36:39]
    buffer_load_dwordx4 v[216:219], v2, s[20:23], s46 offen offset:1024 sc1
    v_mfma_f32_16x16x32_bf16 v[20:23], v[60:63], v[168:171], v[20:23]
    v_mfma_f32_16x16x32_bf16 v[40:43], v[60:63], v[172:175], v[40:43]
    buffer_load_dwordx4 v[220:223], v2, s[20:23], s47 offen offset:1024 sc1
    v_mfma_f32_16x16x32_bf16 v[24:27], v[64:67], v[168:171], v[24:27]
    v_mfma_f32_16x16x32_bf16 v[44:47], v[64:67], v[172:175], v[44:47]
    s_waitcnt vmcnt(12) lgkmcnt(0)
    v_mfma_f32_16x16x32_bf16 v[8:11], v[68:71], v[176:179], v[8:11]
    ds_read_b64_tr_b16 v[48:49], v252 offset:12800
    ds_read_b64_tr_b16 v[50:51], v252 offset:14080
    v_mfma_f32_16x16x32_bf16 v[28:31], v[68:71], v[180:183], v[28:31]
    ds_read_b64_tr_b16 v[52:53], v252 offset:12832
    ds_read_b64_tr_b16 v[54:55], v252 offset:14112
    v_mfma_f32_16x16x32_bf16 v[12:15], v[72:75], v[176:179], v[12:15]
    ds_read_b64_tr_b16 v[56:57], v252 offset:12864
    ds_read_b64_tr_b16 v[58:59], v252 offset:14144
    v_mfma_f32_16x16x32_bf16 v[32:35], v[72:75], v[180:183], v[32:35]
    ds_read_b64_tr_b16 v[60:61], v252 offset:12896
    ds_read_b64_tr_b16 v[62:63], v252 offset:14176
    v_mfma_f32_16x16x32_bf16 v[16:19], v[76:79], v[176:179], v[16:19]
    ds_read_b64_tr_b16 v[64:65], v252 offset:12928
    ds_read_b64_tr_b16 v[66:67], v252 offset:14208
    v_mfma_f32_16x16x32_bf16 v[36:39], v[76:79], v[180:183], v[36:39]
    buffer_load_dwordx4 v[224:227], v2, s[20:23], s46 offen offset:2048 sc1
    v_mfma_f32_16x16x32_bf16 v[20:23], v[80:83], v[176:179], v[20:23]
    v_mfma_f32_16x16x32_bf16 v[40:43], v[80:83], v[180:183], v[40:43]
    buffer_load_dwordx4 v[228:231], v2, s[20:23], s47 offen offset:2048 sc1
    v_mfma_f32_16x16x32_bf16 v[24:27], v[84:87], v[176:179], v[24:27]
    v_mfma_f32_16x16x32_bf16 v[44:47], v[84:87], v[180:183], v[44:47]
    s_waitcnt vmcnt(12) lgkmcnt(0)
    v_mfma_f32_16x16x32_bf16 v[8:11], v[48:51], v[184:187], v[8:11]
    ds_read_b64_tr_b16 v[68:69], v252 offset:19200
    ds_read_b64_tr_b16 v[70:71], v252 offset:20480
    v_mfma_f32_16x16x32_bf16 v[28:31], v[48:51], v[188:191], v[28:31]
    ds_read_b64_tr_b16 v[72:73], v252 offset:19232
    ds_read_b64_tr_b16 v[74:75], v252 offset:20512
    v_mfma_f32_16x16x32_bf16 v[12:15], v[52:55], v[184:187], v[12:15]
    ds_read_b64_tr_b16 v[76:77], v252 offset:19264
    ds_read_b64_tr_b16 v[78:79], v252 offset:20544
    v_mfma_f32_16x16x32_bf16 v[32:35], v[52:55], v[188:191], v[32:35]
    ds_read_b64_tr_b16 v[80:81], v252 offset:19296
    ds_read_b64_tr_b16 v[82:83], v252 offset:20576
    v_mfma_f32_16x16x32_bf16 v[16:19], v[56:59], v[184:187], v[16:19]
    ds_read_b64_tr_b16 v[84:85], v252 offset:19328
    ds_read_b64_tr_b16 v[86:87], v252 offset:20608
    v_mfma_f32_16x16x32_bf16 v[36:39], v[56:59], v[188:191], v[36:39]
    buffer_load_dwordx4 v[232:235], v2, s[20:23], s46 offen offset:3072 sc1
    v_mfma_f32_16x16x32_bf16 v[20:23], v[60:63], v[184:187], v[20:23]
    v_mfma_f32_16x16x32_bf16 v[40:43], v[60:63], v[188:191], v[40:43]
    buffer_load_dwordx4 v[236:239], v2, s[20:23], s47 offen offset:3072 sc1
    v_mfma_f32_16x16x32_bf16 v[24:27], v[64:67], v[184:187], v[24:27]
    v_mfma_f32_16x16x32_bf16 v[44:47], v[64:67], v[188:191], v[44:47]
    s_waitcnt vmcnt(12) lgkmcnt(0)
    v_mfma_f32_16x16x32_bf16 v[8:11], v[68:71], v[192:195], v[8:11]
    ds_read_b64_tr_b16 v[48:49], v253 offset:0
    ds_read_b64_tr_b16 v[50:51], v253 offset:3200
    v_mfma_f32_16x16x32_bf16 v[28:31], v[68:71], v[196:199], v[28:31]
    ds_read_b64_tr_b16 v[52:53], v253 offset:32
    ds_read_b64_tr_b16 v[54:55], v253 offset:3232
    v_mfma_f32_16x16x32_bf16 v[12:15], v[72:75], v[192:195], v[12:15]
    ds_read_b64_tr_b16 v[56:57], v253 offset:64
    ds_read_b64_tr_b16 v[58:59], v253 offset:3264
    v_mfma_f32_16x16x32_bf16 v[32:35], v[72:75], v[196:199], v[32:35]
    ds_read_b64_tr_b16 v[60:61], v253 offset:96
    ds_read_b64_tr_b16 v[62:63], v253 offset:3296
    v_mfma_f32_16x16x32_bf16 v[16:19], v[76:79], v[192:195], v[16:19]
    ds_read_b64_tr_b16 v[64:65], v253 offset:128
    ds_read_b64_tr_b16 v[66:67], v253 offset:3328
    v_mfma_f32_16x16x32_bf16 v[36:39], v[76:79], v[196:199], v[36:39]
    buffer_load_dwordx2 v[240:241], v255, s[20:23], s48 offen offset:3072 sc1
    buffer_load_dwordx2 v[242:243], v255, s[20:23], s48 offen offset:3200 sc1
    buffer_load_dwordx2 v[244:245], v255, s[20:23], s49 offen offset:3072 sc1
    v_mfma_f32_16x16x32_bf16 v[20:23], v[80:83], v[192:195], v[20:23]
    v_mfma_f32_16x16x32_bf16 v[40:43], v[80:83], v[196:199], v[40:43]
    buffer_load_dwordx2 v[246:247], v255, s[20:23], s49 offen offset:3200 sc1
    v_mfma_f32_16x16x32_bf16 v[24:27], v[84:87], v[192:195], v[24:27]
    v_mfma_f32_16x16x32_bf16 v[44:47], v[84:87], v[196:199], v[44:47]
    s_waitcnt vmcnt(12) lgkmcnt(0)
    v_add_u32 v252, 0x8000, v252
    v_add_u32 v253, 0x8000, v253
    v_mfma_f32_16x16x32_bf16 v[8:11], v[48:51], v[200:203], v[8:11]
    ds_read_b64_tr_b16 v[68:69], v252 offset:0
    ds_read_b64_tr_b16 v[70:71], v252 offset:1280
    v_mfma_f32_16x16x32_bf16 v[28:31], v[48:51], v[204:207], v[28:31]
    ds_read_b64_tr_b16 v[72:73], v252 offset:32
    ds_read_b64_tr_b16 v[74:75], v252 offset:1312
    v_mfma_f32_16x16x32_bf16 v[12:15], v[52:55], v[200:203], v[12:15]
    ds_read_b64_tr_b16 v[76:77], v252 offset:64
    ds_read_b64_tr_b16 v[78:79], v252 offset:1344
    v_mfma_f32_16x16x32_bf16 v[32:35], v[52:55], v[204:207], v[32:35]
    ds_read_b64_tr_b16 v[80:81], v252 offset:96
    ds_read_b64_tr_b16 v[82:83], v252 offset:1376
    v_mfma_f32_16x16x32_bf16 v[16:19], v[56:59], v[200:203], v[16:19]
    ds_read_b64_tr_b16 v[84:85], v252 offset:128
    ds_read_b64_tr_b16 v[86:87], v252 offset:1408
    v_mfma_f32_16x16x32_bf16 v[36:39], v[56:59], v[204:207], v[36:39]
    v_mfma_f32_16x16x32_bf16 v[20:23], v[60:63], v[200:203], v[20:23]
    v_mfma_f32_16x16x32_bf16 v[40:43], v[60:63], v[204:207], v[40:43]
    v_mfma_f32_16x16x32_bf16 v[24:27], v[64:67], v[200:203], v[24:27]
    v_mfma_f32_16x16x32_bf16 v[44:47], v[64:67], v[204:207], v[44:47]
    s_waitcnt vmcnt(10) lgkmcnt(0)
    v_mfma_f32_16x16x32_bf16 v[8:11], v[68:71], v[208:211], v[8:11]
    ds_read_b64_tr_b16 v[48:49], v252 offset:6400
    ds_read_b64_tr_b16 v[50:51], v252 offset:7680
    v_mfma_f32_16x16x32_bf16 v[28:31], v[68:71], v[212:215], v[28:31]
    ds_read_b64_tr_b16 v[52:53], v252 offset:6432
    ds_read_b64_tr_b16 v[54:55], v252 offset:7712
    v_mfma_f32_16x16x32_bf16 v[12:15], v[72:75], v[208:211], v[12:15]
    ds_read_b64_tr_b16 v[56:57], v252 offset:6464
    ds_read_b64_tr_b16 v[58:59], v252 offset:7744
    v_mfma_f32_16x16x32_bf16 v[32:35], v[72:75], v[212:215], v[32:35]
    ds_read_b64_tr_b16 v[60:61], v252 offset:6496
    ds_read_b64_tr_b16 v[62:63], v252 offset:7776
    v_mfma_f32_16x16x32_bf16 v[16:19], v[76:79], v[208:211], v[16:19]
    ds_read_b64_tr_b16 v[64:65], v252 offset:6528
    ds_read_b64_tr_b16 v[66:67], v252 offset:7808
    v_mfma_f32_16x16x32_bf16 v[36:39], v[76:79], v[212:215], v[36:39]
    v_mfma_f32_16x16x32_bf16 v[20:23], v[80:83], v[208:211], v[20:23]
    v_mfma_f32_16x16x32_bf16 v[40:43], v[80:83], v[212:215], v[40:43]
    v_mfma_f32_16x16x32_bf16 v[24:27], v[84:87], v[208:211], v[24:27]
    v_mfma_f32_16x16x32_bf16 v[44:47], v[84:87], v[212:215], v[44:47]
    s_waitcnt vmcnt(8) lgkmcnt(0)
    v_mfma_f32_16x16x32_bf16 v[8:11], v[48:51], v[216:219], v[8:11]
    ds_read_b64_tr_b16 v[68:69], v252 offset:12800
    ds_read_b64_tr_b16 v[70:71], v252 offset:14080
    v_mfma_f32_16x16x32_bf16 v[28:31], v[48:51], v[220:223], v[28:31]
    ds_read_b64_tr_b16 v[72:73], v252 offset:12832
    ds_read_b64_tr_b16 v[74:75], v252 offset:14112
    v_mfma_f32_16x16x32_bf16 v[12:15], v[52:55], v[216:219], v[12:15]
    ds_read_b64_tr_b16 v[76:77], v252 offset:12864
    ds_read_b64_tr_b16 v[78:79], v252 offset:14144
    v_mfma_f32_16x16x32_bf16 v[32:35], v[52:55], v[220:223], v[32:35]
    ds_read_b64_tr_b16 v[80:81], v252 offset:12896
    ds_read_b64_tr_b16 v[82:83], v252 offset:14176
    v_mfma_f32_16x16x32_bf16 v[16:19], v[56:59], v[216:219], v[16:19]
    ds_read_b64_tr_b16 v[84:85], v252 offset:12928
    ds_read_b64_tr_b16 v[86:87], v252 offset:14208
    v_mfma_f32_16x16x32_bf16 v[36:39], v[56:59], v[220:223], v[36:39]
    v_mfma_f32_16x16x32_bf16 v[20:23], v[60:63], v[216:219], v[20:23]
    v_mfma_f32_16x16x32_bf16 v[40:43], v[60:63], v[220:223], v[40:43]
    v_mfma_f32_16x16x32_bf16 v[24:27], v[64:67], v[216:219], v[24:27]
    v_mfma_f32_16x16x32_bf16 v[44:47], v[64:67], v[220:223], v[44:47]
    s_waitcnt vmcnt(6) lgkmcnt(0)
    v_mfma_f32_16x16x32_bf16 v[8:11], v[68:71], v[224:227], v[8:11]
    ds_read_b64_tr_b16 v[48:49], v252 offset:19200
    ds_read_b64_tr_b16 v[50:51], v252 offset:20480
    v_mfma_f32_16x16x32_bf16 v[28:31], v[68:71], v[228:231], v[28:31]
    ds_read_b64_tr_b16 v[52:53], v252 offset:19232
    ds_read_b64_tr_b16 v[54:55], v252 offset:20512
    v_mfma_f32_16x16x32_bf16 v[12:15], v[72:75], v[224:227], v[12:15]
    ds_read_b64_tr_b16 v[56:57], v252 offset:19264
    ds_read_b64_tr_b16 v[58:59], v252 offset:20544
    v_mfma_f32_16x16x32_bf16 v[32:35], v[72:75], v[228:231], v[32:35]
    ds_read_b64_tr_b16 v[60:61], v252 offset:19296
    ds_read_b64_tr_b16 v[62:63], v252 offset:20576
    v_mfma_f32_16x16x32_bf16 v[16:19], v[76:79], v[224:227], v[16:19]
    ds_read_b64_tr_b16 v[64:65], v252 offset:19328
    ds_read_b64_tr_b16 v[66:67], v252 offset:20608
    v_mfma_f32_16x16x32_bf16 v[36:39], v[76:79], v[228:231], v[36:39]
    v_mfma_f32_16x16x32_bf16 v[20:23], v[80:83], v[224:227], v[20:23]
    v_mfma_f32_16x16x32_bf16 v[40:43], v[80:83], v[228:231], v[40:43]
    v_mfma_f32_16x16x32_bf16 v[24:27], v[84:87], v[224:227], v[24:27]
    v_mfma_f32_16x16x32_bf16 v[44:47], v[84:87], v[228:231], v[44:47]
    s_waitcnt vmcnt(4) lgkmcnt(0)
    v_mfma_f32_16x16x32_bf16 v[8:11], v[48:51], v[232:235], v[8:11]
    ds_read_b64_tr_b16 v[68:69], v253 offset:0
    ds_read_b64_tr_b16 v[70:71], v253 offset:3200
    v_mfma_f32_16x16x32_bf16 v[28:31], v[48:51], v[236:239], v[28:31]
    ds_read_b64_tr_b16 v[72:73], v253 offset:32
    ds_read_b64_tr_b16 v[74:75], v253 offset:3232
    v_mfma_f32_16x16x32_bf16 v[12:15], v[52:55], v[232:235], v[12:15]
    ds_read_b64_tr_b16 v[76:77], v253 offset:64
    ds_read_b64_tr_b16 v[78:79], v253 offset:3264
    v_mfma_f32_16x16x32_bf16 v[32:35], v[52:55], v[236:239], v[32:35]
    ds_read_b64_tr_b16 v[80:81], v253 offset:96
    ds_read_b64_tr_b16 v[82:83], v253 offset:3296
    v_mfma_f32_16x16x32_bf16 v[16:19], v[56:59], v[232:235], v[16:19]
    ds_read_b64_tr_b16 v[84:85], v253 offset:128
    ds_read_b64_tr_b16 v[86:87], v253 offset:3328
    v_mfma_f32_16x16x32_bf16 v[36:39], v[56:59], v[236:239], v[36:39]
    v_mfma_f32_16x16x32_bf16 v[20:23], v[60:63], v[232:235], v[20:23]
    v_mfma_f32_16x16x32_bf16 v[40:43], v[60:63], v[236:239], v[40:43]
    v_mfma_f32_16x16x32_bf16 v[24:27], v[64:67], v[232:235], v[24:27]
    v_mfma_f32_16x16x32_bf16 v[44:47], v[64:67], v[236:239], v[44:47]
    s_waitcnt vmcnt(0) lgkmcnt(0)
    v_mfma_f32_16x16x32_bf16 v[8:11], v[68:71], v[240:243], v[8:11]
    v_mfma_f32_16x16x32_bf16 v[28:31], v[68:71], v[244:247], v[28:31]
    v_mfma_f32_16x16x32_bf16 v[12:15], v[72:75], v[240:243], v[12:15]
    v_mfma_f32_16x16x32_bf16 v[32:35], v[72:75], v[244:247], v[32:35]
    v_mfma_f32_16x16x32_bf16 v[16:19], v[76:79], v[240:243], v[16:19]
    v_mfma_f32_16x16x32_bf16 v[36:39], v[76:79], v[244:247], v[36:39]
    v_mfma_f32_16x16x32_bf16 v[20:23], v[80:83], v[240:243], v[20:23]
    v_mfma_f32_16x16x32_bf16 v[40:43], v[80:83], v[244:247], v[40:43]
    v_mfma_f32_16x16x32_bf16 v[24:27], v[84:87], v[240:243], v[24:27]
    v_mfma_f32_16x16x32_bf16 v[44:47], v[84:87], v[244:247], v[44:47]
    v_and_b32 v4, 15, v0
    v_lshrrev_b32 v5, 4, v0
    v_mul_u32_u24 v4, 2560, v4
    v_lshl_add_u32 v7, v5, 3, v4
    v_and_b32 v6, 1, v5
    v_lshl_add_u32 v4, v6, 5, v4
    v_lshrrev_b32 v6, 1, v5
    v_lshl_add_u32 v4, v6, 4, v4
    s_mul_i32 s46, s41, 81920
    s_and_b32 s47, s37, 1
    s_mul_i32 s47, s47, 1280
    s_add_u32 s46, s46, s47
    s_mul_i32 s47, s95, 160
    s_add_u32 s46, s46, s47
    s_add_u32 s47, s46, 40960
    v_cvt_pk_bf16_f32 v48, v8, v9
    v_cvt_pk_bf16_f32 v49, v10, v11
    v_cvt_pk_bf16_f32 v50, v12, v13
    v_cvt_pk_bf16_f32 v51, v14, v15
    v_cvt_pk_bf16_f32 v52, v16, v17
    v_cvt_pk_bf16_f32 v53, v18, v19
    v_cvt_pk_bf16_f32 v54, v20, v21
    v_cvt_pk_bf16_f32 v55, v22, v23
    v_cvt_pk_bf16_f32 v56, v24, v25
    v_cvt_pk_bf16_f32 v57, v26, v27
    v_permlane16_swap_b32 v48, v50
    v_permlane16_swap_b32 v49, v51
    v_permlane16_swap_b32 v52, v54
    v_permlane16_swap_b32 v53, v55
    buffer_store_dwordx2 v[56:57], v7, s[28:31], s46 offen offset:128
    buffer_store_dwordx4 v[48:51], v4, s[28:31], s46 offen
    buffer_store_dwordx4 v[52:55], v4, s[28:31], s46 offen offset:64
    v_cvt_pk_bf16_f32 v68, v28, v29
    v_cvt_pk_bf16_f32 v69, v30, v31
    v_cvt_pk_bf16_f32 v70, v32, v33
    v_cvt_pk_bf16_f32 v71, v34, v35
    v_cvt_pk_bf16_f32 v72, v36, v37
    v_cvt_pk_bf16_f32 v73, v38, v39
    v_cvt_pk_bf16_f32 v74, v40, v41
    v_cvt_pk_bf16_f32 v75, v42, v43
    v_cvt_pk_bf16_f32 v76, v44, v45
    v_cvt_pk_bf16_f32 v77, v46, v47
    v_permlane16_swap_b32 v68, v70
    v_permlane16_swap_b32 v69, v71
    v_permlane16_swap_b32 v72, v74
    v_permlane16_swap_b32 v73, v75
    buffer_store_dwordx2 v[76:77], v7, s[28:31], s47 offen offset:128
    buffer_store_dwordx4 v[68:71], v4, s[28:31], s47 offen
    buffer_store_dwordx4 v[72:75], v4, s[28:31], s47 offen offset:64
    s_endpgm
concat_heads__sliding_block__grouped_kv_mqa__prompt_kernel_end:
    s_endpgm
concat_heads__sliding_block__grouped_kv_mqa__prompt_kernel_g0:
    s_cmp_lt_u32 s94, 4
    s_cbranch_scc1 concat_heads__sliding_block__grouped_kv_mqa__prompt_kernel_g0s
    s_cmp_eq_u32 s94, 7
    s_cbranch_scc1 concat_heads__sliding_block__grouped_kv_mqa__prompt_kernel_g02
concat_heads__sliding_block__grouped_kv_mqa__prompt_kernel_g0k:
    s_cmp_lt_u32 s43, s59
    s_cselect_b32 s41, s40, 1073741824
    s_mov_b32 m0, s42
    s_add_u32 s40, s40, 4096
    buffer_load_dwordx4 v2, s[20:23], s41 offen sc1 lds
    s_add_u32 s42, s42, 4096
    s_add_u32 s43, s43, 4
    s_cmp_lt_u32 s43, s59
    s_cselect_b32 s41, s40, 1073741824
    s_mov_b32 m0, s42
    s_add_u32 s40, s40, 4096
    buffer_load_dwordx4 v2, s[20:23], s41 offen sc1 lds
    s_add_u32 s42, s42, 4096
    s_add_u32 s43, s43, 4
    s_cmp_lt_u32 s43, s59
    s_cselect_b32 s41, s40, 1073741824
    s_mov_b32 m0, s42
    s_add_u32 s40, s40, 4096
    buffer_load_dwordx4 v2, s[20:23], s41 offen sc1 lds
    s_add_u32 s42, s42, 4096
    s_add_u32 s43, s43, 4
concat_heads__sliding_block__grouped_kv_mqa__prompt_kernel_g0w:
    s_mov_b64 exec, s[48:49]
    s_mov_b32 m0, s50
    s_add_u32 s50, s50, 3200
    buffer_load_dwordx4 v3, s[24:27], s51 offen lds
    s_add_u32 s51, s51, 25600
    s_mov_b32 m0, s50
    s_add_u32 s50, s50, 3200
    buffer_load_dwordx4 v3, s[24:27], s51 offen lds
    s_add_u32 s51, s51, 25600
    s_mov_b64 exec, -1
    s_waitcnt lgkmcnt(0)
    s_barrier
    s_branch concat_heads__sliding_block__grouped_kv_mqa__prompt_kernel_qac
concat_heads__sliding_block__grouped_kv_mqa__prompt_kernel_g0s:
    s_cmp_eq_u32 s94, 3
    s_cbranch_scc1 concat_heads__sliding_block__grouped_kv_mqa__prompt_kernel_g03
    s_cmp_eq_u32 s94, 2
    s_cbranch_scc1 concat_heads__sliding_block__grouped_kv_mqa__prompt_kernel_g02
    s_cmp_eq_u32 s38, 3
    s_cbranch_scc1 concat_heads__sliding_block__grouped_kv_mqa__prompt_kernel_g0w
    s_cmp_eq_u32 s94, 0
    s_cbranch_scc1 concat_heads__sliding_block__grouped_kv_mqa__prompt_kernel_st
    s_cmp_eq_u32 s38, 2
    s_cbranch_scc1 concat_heads__sliding_block__grouped_kv_mqa__prompt_kernel_stv2
    s_branch concat_heads__sliding_block__grouped_kv_mqa__prompt_kernel_stq2
concat_heads__sliding_block__grouped_kv_mqa__prompt_kernel_g02:
    s_waitcnt vmcnt(0)
    s_branch concat_heads__sliding_block__grouped_kv_mqa__prompt_kernel_g0w
concat_heads__sliding_block__grouped_kv_mqa__prompt_kernel_g03:
    buffer_load_dword v12, v21, s[20:23], 0 offen sc1
    s_lshl_b32 s42, s36, 10
    s_add_u32 s40, s42, s58
    s_add_u32 s42, s42, 58368
    s_add_u32 s43, s36, s59
    s_sub_u32 s43, s43, 44
    s_waitcnt vmcnt(0)
    s_mov_b32 s3, 0
concat_heads__sliding_block__grouped_kv_mqa__prompt_kernel_sppa:
    v_cmp_gt_u32 vcc, 1, v12
    s_add_u32 s3, s3, 1
    s_cbranch_vccz concat_heads__sliding_block__grouped_kv_mqa__prompt_kernel_sdpa
    s_cmp_gt_u32 s3, 400000
    s_cbranch_scc1 concat_heads__sliding_block__grouped_kv_mqa__prompt_kernel_sdpa
    s_sleep 1
    buffer_load_dword v12, v21, s[20:23], 0 offen sc1
    s_waitcnt vmcnt(0)
    s_branch concat_heads__sliding_block__grouped_kv_mqa__prompt_kernel_sppa
concat_heads__sliding_block__grouped_kv_mqa__prompt_kernel_sdpa:
    s_mov_b32 s44, 0xf1493f80
    v_mov_b32 v216, 0x3f803f80
    s_cmp_lt_u32 s97, 8
    s_cselect_b32 s45, s44, 0x3f80
    v_mov_b32 v217, s45
    v_mov_b32 v218, 0x3f803f80
    s_cmp_lt_u32 s97, 7
    s_cselect_b32 s45, s44, 0x3f80
    v_mov_b32 v219, s45
    v_mov_b32 v220, 0x3f803f80
    s_cmp_lt_u32 s97, 6
    s_cselect_b32 s45, s44, 0x3f80
    v_mov_b32 v221, s45
    v_mov_b32 v222, 0x3f803f80
    s_cmp_lt_u32 s97, 5
    s_cselect_b32 s45, s44, 0x3f80
    v_mov_b32 v223, s45
    v_mov_b32 v224, 0x3f803f80
    s_cmp_lt_u32 s97, 4
    s_cselect_b32 s45, s44, 0x3f80
    v_mov_b32 v225, s45
    v_mov_b32 v226, 0x3f803f80
    s_cmp_lt_u32 s97, 3
    s_cselect_b32 s45, s44, 0x3f80
    v_mov_b32 v227, s45
    v_mov_b32 v228, 0x3f803f80
    s_cmp_lt_u32 s97, 2
    s_cselect_b32 s45, s44, 0x3f80
    v_mov_b32 v229, s45
    v_mov_b32 v230, 0x3f803f80
    s_cmp_lt_u32 s97, 1
    s_cselect_b32 s45, s44, 0x3f80
    v_mov_b32 v231, s45
    v_mov_b32 v232, 0x3f803f80
    v_mov_b32 v233, 0x3f80
    s_lshl_b32 s44, s96, 6
    s_add_u32 s44, s44, s97
    s_mul_i32 s44, s44, 1280
    s_add_u32 s44, s44, 5951488
    v_and_b32 v8, 31, v0
    v_lshlrev_b32 v8, 3, v8
    buffer_load_dwordx4 v[24:27], v2, s[20:23], s44 offen sc1
    s_mov_b32 exec_hi, 0
    buffer_load_dwordx2 v[28:29], v8, s[20:23], s44 offen offset:1024 sc1
    s_mov_b32 exec_hi, -1
    s_branch concat_heads__sliding_block__grouped_kv_mqa__prompt_kernel_g0k
concat_heads__sliding_block__grouped_kv_mqa__prompt_kernel_g1:
    s_cmp_eq_u32 s94, 3
    s_cbranch_scc1 concat_heads__sliding_block__grouped_kv_mqa__prompt_kernel_g1a
    s_cmp_eq_u32 s94, 2
    s_cbranch_scc0 concat_heads__sliding_block__grouped_kv_mqa__prompt_kernel_qac
    s_cmp_eq_u32 s36, 7
    s_cbranch_scc0 concat_heads__sliding_block__grouped_kv_mqa__prompt_kernel_qac
    s_mov_b64 exec, 1
    v_mov_b32 v13, 1
    buffer_store_dword v13, off, s[20:23], s93 sc1
    s_mov_b64 exec, -1
    s_branch concat_heads__sliding_block__grouped_kv_mqa__prompt_kernel_qac
concat_heads__sliding_block__grouped_kv_mqa__prompt_kernel_g1a:
    s_mov_b32 s44, 0xf1493f80
    v_mov_b32 v216, 0x3f803f80
    s_cmp_lt_u32 s97, 8
    s_cselect_b32 s45, s44, 0x3f80
    v_mov_b32 v217, s45
    v_mov_b32 v218, 0x3f803f80
    s_cmp_lt_u32 s97, 7
    s_cselect_b32 s45, s44, 0x3f80
    v_mov_b32 v219, s45
    v_mov_b32 v220, 0x3f803f80
    s_cmp_lt_u32 s97, 6
    s_cselect_b32 s45, s44, 0x3f80
    v_mov_b32 v221, s45
    v_mov_b32 v222, 0x3f803f80
    s_cmp_lt_u32 s97, 5
    s_cselect_b32 s45, s44, 0x3f80
    v_mov_b32 v223, s45
    v_mov_b32 v224, 0x3f803f80
    s_cmp_lt_u32 s97, 4
    s_cselect_b32 s45, s44, 0x3f80
    v_mov_b32 v225, s45
    v_mov_b32 v226, 0x3f803f80
    s_cmp_lt_u32 s97, 3
    s_cselect_b32 s45, s44, 0x3f80
    v_mov_b32 v227, s45
    v_mov_b32 v228, 0x3f803f80
    s_cmp_lt_u32 s97, 2
    s_cselect_b32 s45, s44, 0x3f80
    v_mov_b32 v229, s45
    v_mov_b32 v230, 0x3f803f80
    s_cmp_lt_u32 s97, 1
    s_cselect_b32 s45, s44, 0x3f80
    v_mov_b32 v231, s45
    v_mov_b32 v232, 0x3f803f80
    v_mov_b32 v233, 0x3f80
    s_lshl_b32 s44, s96, 6
    s_add_u32 s44, s44, s97
    s_mul_i32 s44, s44, 1280
    s_add_u32 s44, s44, 5951488
    v_and_b32 v8, 31, v0
    v_lshlrev_b32 v8, 3, v8
    buffer_load_dwordx4 v[24:27], v2, s[20:23], s44 offen sc1
    s_mov_b32 exec_hi, 0
    buffer_load_dwordx2 v[28:29], v8, s[20:23], s44 offen offset:1024 sc1
    s_mov_b32 exec_hi, -1
    s_branch concat_heads__sliding_block__grouped_kv_mqa__prompt_kernel_qac
concat_heads__sliding_block__grouped_kv_mqa__prompt_kernel_g1w:
    s_cmp_eq_u32 s94, 7
    s_cbranch_scc0 concat_heads__sliding_block__grouped_kv_mqa__prompt_kernel_qac
    s_and_b32 s42, s36, 3
    s_mul_i32 s40, s42, 800
    s_add_u32 m0, s40, 32768
    s_mul_i32 s41, s42, 6400
    s_mul_i32 s42, s95, 160
    s_add_u32 s41, s41, s42
    s_add_u32 s41, s41, 614400
    s_mov_b32 s42, 8
    s_mov_b64 exec, s[48:49]
concat_heads__sliding_block__grouped_kv_mqa__prompt_kernel_wb3:
    buffer_load_dwordx4 v3, s[24:27], s41 offen lds
    s_add_u32 m0, m0, 3200
    s_add_u32 s41, s41, 25600
    s_sub_u32 s42, s42, 1
    s_cmp_lg_u32 s42, 0
    s_cbranch_scc1 concat_heads__sliding_block__grouped_kv_mqa__prompt_kernel_wb3
    s_mov_b64 exec, -1
    s_branch concat_heads__sliding_block__grouped_kv_mqa__prompt_kernel_qac
concat_heads__sliding_block__grouped_kv_mqa__prompt_kernel_st:
    v_and_b32 v7, 15, v0
    v_lshrrev_b32 v8, 4, v0
    s_lshl_b32 s44, s92, 9
    s_lshl_b32 s45, s39, 2
    s_add_u32 s44, s44, s45
    s_and_b32 s45, s36, 2
    s_add_u32 s44, s44, s45
    s_and_b32 s45, s36, 1
    s_lshl_b32 s45, s45, 8
    s_add_u32 s44, s44, s45
    s_cmp_eq_u32 s38, 2
    s_cbranch_scc1 concat_heads__sliding_block__grouped_kv_mqa__prompt_kernel_stv
    s_cmp_eq_u32 s38, 1
    s_cselect_b32 s45, 1536, 0
    s_cselect_b32 s46, 0, 5951488
    s_add_u32 s45, s45, 1280
    s_mul_i32 s44, s44, s45
    s_add_u32 s44, s44, s46
    s_lshl_b32 s46, s45, 6
    s_add_u32 s45, s45, s44
    v_mul_u32_u24 v8, s46, v8
    v_lshl_add_u32 v10, v7, 4, v8
    v_lshl_add_u32 v8, v7, 3, v8
    buffer_store_dwordx4 v[180:183], v10, s[20:23], s44 offen offset:0 sc1
    buffer_store_dwordx4 v[184:187], v10, s[20:23], s44 offen offset:512 sc1
    buffer_store_dwordx2 v[188:189], v8, s[20:23], s44 offen offset:1024 sc1
    buffer_store_dwordx4 v[190:193], v10, s[20:23], s44 offen offset:256 sc1
    buffer_store_dwordx4 v[194:197], v10, s[20:23], s44 offen offset:768 sc1
    buffer_store_dwordx2 v[198:199], v8, s[20:23], s44 offen offset:1152 sc1
    s_branch concat_heads__sliding_block__grouped_kv_mqa__prompt_kernel_g0w
concat_heads__sliding_block__grouped_kv_mqa__prompt_kernel_stq2:
    buffer_store_dwordx4 v[200:203], v10, s[20:23], s45 offen offset:0 sc1
    buffer_store_dwordx4 v[204:207], v10, s[20:23], s45 offen offset:512 sc1
    buffer_store_dwordx2 v[208:209], v8, s[20:23], s45 offen offset:1024 sc1
    buffer_store_dwordx4 v[210:213], v10, s[20:23], s45 offen offset:256 sc1
    buffer_store_dwordx4 v[214:217], v10, s[20:23], s45 offen offset:768 sc1
    buffer_store_dwordx2 v[218:219], v8, s[20:23], s45 offen offset:1152 sc1
    s_branch concat_heads__sliding_block__grouped_kv_mqa__prompt_kernel_g0w
concat_heads__sliding_block__grouped_kv_mqa__prompt_kernel_stv:
    v_mul_u32_u24 v8, 384, v8
    v_lshl_add_u32 v10, v7, 4, v8
    v_lshrrev_b32 v11, 2, v7
    v_mul_u32_u24 v11, 180160, v11
    v_add_u32 v11, v11, v10
    s_mul_i32 s44, s44, 2816
    s_add_u32 s44, s44, 1280
    s_add_u32 s45, s44, 256
    buffer_store_dwordx4 v[180:183], v10, s[20:23], s44 offen offset:0 sc1
    buffer_store_dwordx4 v[184:187], v10, s[20:23], s44 offen offset:2816 sc1
    s_add_u32 s44, s44, 180224
    buffer_store_dwordx4 v[188:191], v10, s[20:23], s44 offen offset:0 sc1
    buffer_store_dwordx4 v[192:195], v10, s[20:23], s44 offen offset:2816 sc1
    s_add_u32 s44, s44, 180224
    buffer_store_dwordx4 v[196:199], v10, s[20:23], s44 offen offset:0 sc1
    buffer_store_dwordx4 v[200:203], v10, s[20:23], s44 offen offset:2816 sc1
    s_add_u32 s44, s44, 180224
    s_branch concat_heads__sliding_block__grouped_kv_mqa__prompt_kernel_g0w
concat_heads__sliding_block__grouped_kv_mqa__prompt_kernel_stv2:
    buffer_store_dwordx4 v[204:207], v10, s[20:23], s44 offen offset:0 sc1
    buffer_store_dwordx4 v[208:211], v10, s[20:23], s44 offen offset:2816 sc1
    buffer_store_dwordx4 v[212:215], v11, s[20:23], s45 offen offset:0 sc1
    buffer_store_dwordx4 v[216:219], v11, s[20:23], s45 offen offset:2816 sc1
    s_branch concat_heads__sliding_block__grouped_kv_mqa__prompt_kernel_g0w
concat_heads__sliding_block__grouped_kv_mqa__prompt_kernel_t3go:
    s_cmp_ge_u32 s36, 4
    s_cbranch_scc1 concat_heads__sliding_block__grouped_kv_mqa__prompt_kernel_t3l
    v_and_b32 v7, 15, v0
    v_lshrrev_b32 v8, 4, v0
    v_bfe_u32 v10, v0, 1, 3
    v_xor_b32 v10, v10, v8
    v_lshlrev_b32 v10, 4, v10
    v_lshl_add_u32 v10, v7, 7, v10
    s_and_b32 s41, s36, 1
    s_lshl_b32 s2, s41, 11
    v_add_u32 v76, s2, v10
    v_xor_b32 v77, 64, v76
    v_bfe_u32 v10, v0, 2, 2
    v_lshl_add_u32 v10, v8, 3, v10
    v_mul_u32_u24 v10, 40, v10
    v_and_b32 v11, 3, v0
    v_lshl_add_u32 v10, v11, 3, v10
    s_lshr_b32 s2, s36, 1
    s_lshl_b32 s2, s2, 15
    s_add_u32 s2, s2, 40960
    v_add_u32 v78, s2, v10
    v_mov_b32 v192, 0
    v_mov_b32 v193, 0
    v_mov_b32 v194, 0
    v_mov_b32 v195, 0
    v_mov_b32 v196, 0
    v_mov_b32 v197, 0
    v_mov_b32 v198, 0
    v_mov_b32 v199, 0
    s_mov_b32 s94, 5
    s_mul_i32 s45, s39, 2816
    s_add_u32 s45, s45, 5767168
    s_waitcnt vmcnt(1)
    s_barrier
    ds_read_b128 v[88:91], v76 offset:0
    ds_read_b64_tr_b16 v[96:97], v78 offset:0
    ds_read_b64_tr_b16 v[98:99], v78 offset:160
    ds_read_b64_tr_b16 v[100:101], v78 offset:32
    ds_read_b64_tr_b16 v[102:103], v78 offset:192
    ds_read_b128 v[92:95], v77 offset:0
    ds_read_b64_tr_b16 v[104:105], v78 offset:1280
    ds_read_b64_tr_b16 v[106:107], v78 offset:1440
    ds_read_b64_tr_b16 v[108:109], v78 offset:1312
    ds_read_b64_tr_b16 v[110:111], v78 offset:1472
    s_cmp_ge_u32 s36, 2
    s_cbranch_scc1 concat_heads__sliding_block__grouped_kv_mqa__prompt_kernel_t3v
concat_heads__sliding_block__grouped_kv_mqa__prompt_kernel_t3k:
    ds_read_b128 v[112:115], v76 offset:4096
    ds_read_b64_tr_b16 v[120:121], v78 offset:2560
    ds_read_b64_tr_b16 v[122:123], v78 offset:2720
    ds_read_b64_tr_b16 v[124:125], v78 offset:2592
    ds_read_b64_tr_b16 v[126:127], v78 offset:2752
    ds_read_b128 v[116:119], v77 offset:4096
    ds_read_b64_tr_b16 v[128:129], v78 offset:3840
    ds_read_b64_tr_b16 v[130:131], v78 offset:4000
    ds_read_b64_tr_b16 v[132:133], v78 offset:3872
    ds_read_b64_tr_b16 v[134:135], v78 offset:4032
    s_waitcnt lgkmcnt(10)
    v_mfma_f32_16x16x32_bf16 v[192:195], v[96:99], v[88:91], v[192:195]
    v_mfma_f32_16x16x32_bf16 v[196:199], v[100:103], v[88:91], v[196:199]
    v_mfma_f32_16x16x32_bf16 v[192:195], v[104:107], v[92:95], v[192:195]
    v_mfma_f32_16x16x32_bf16 v[196:199], v[108:111], v[92:95], v[196:199]
    ds_read_b128 v[88:91], v76 offset:8192
    ds_read_b64_tr_b16 v[96:97], v78 offset:5120
    ds_read_b64_tr_b16 v[98:99], v78 offset:5280
    ds_read_b64_tr_b16 v[100:101], v78 offset:5152
    ds_read_b64_tr_b16 v[102:103], v78 offset:5312
    ds_read_b128 v[92:95], v77 offset:8192
    ds_read_b64_tr_b16 v[104:105], v78 offset:6400
    ds_read_b64_tr_b16 v[106:107], v78 offset:6560
    ds_read_b64_tr_b16 v[108:109], v78 offset:6432
    ds_read_b64_tr_b16 v[110:111], v78 offset:6592
    s_waitcnt lgkmcnt(10)
    v_mfma_f32_16x16x32_bf16 v[192:195], v[120:123], v[112:115], v[192:195]
    v_mfma_f32_16x16x32_bf16 v[196:199], v[124:127], v[112:115], v[196:199]
    v_mfma_f32_16x16x32_bf16 v[192:195], v[128:131], v[116:119], v[192:195]
    v_mfma_f32_16x16x32_bf16 v[196:199], v[132:135], v[116:119], v[196:199]
    v_add_u32 v76, 8192, v76
    v_add_u32 v77, 8192, v77
    v_add_u32 v78, 5120, v78
    s_sub_u32 s94, s94, 1
    s_cmp_lg_u32 s94, 0
    s_cbranch_scc1 concat_heads__sliding_block__grouped_kv_mqa__prompt_kernel_t3k
    v_and_b32 v7, 15, v0
    v_lshrrev_b32 v8, 4, v0
    v_and_b32 v11, 1, v8
    v_lshrrev_b32 v10, 1, v8
    s_nop 1
    v_cvt_pk_bf16_f32 v136, v192, v193
    v_cvt_pk_bf16_f32 v137, v194, v195
    v_cvt_pk_bf16_f32 v138, v196, v197
    v_cvt_pk_bf16_f32 v139, v198, v199
    v_lshlrev_b32 v10, 9, v10
    v_lshl_add_u32 v10, v7, 4, v10
    v_lshl_add_u32 v10, v11, 3, v10
    v_lshlrev_b32 v7, 3, v7
    v_lshl_add_u32 v11, v8, 28, v7
    s_lshl_b32 s47, s41, 8
    s_add_u32 s47, s47, s45
    s_lshl_b32 s46, s41, 7
    s_add_u32 s46, s46, s45
    buffer_store_dwordx2 v[136:137], v10, s[20:23], s47 offen sc1
    buffer_store_dwordx2 v[138:139], v11, s[20:23], s46 offen offset:1024 sc1
    s_branch concat_heads__sliding_block__grouped_kv_mqa__prompt_kernel_t3e
concat_heads__sliding_block__grouped_kv_mqa__prompt_kernel_t3v:
    ds_read_b128 v[112:115], v76 offset:4096
    ds_read_b64_tr_b16 v[120:121], v78 offset:2560
    ds_read_b64_tr_b16 v[122:123], v78 offset:2720
    ds_read_b64_tr_b16 v[124:125], v78 offset:2592
    ds_read_b64_tr_b16 v[126:127], v78 offset:2752
    ds_read_b128 v[116:119], v77 offset:4096
    ds_read_b64_tr_b16 v[128:129], v78 offset:3840
    ds_read_b64_tr_b16 v[130:131], v78 offset:4000
    ds_read_b64_tr_b16 v[132:133], v78 offset:3872
    ds_read_b64_tr_b16 v[134:135], v78 offset:4032
    s_waitcnt lgkmcnt(10)
    v_mfma_f32_16x16x32_bf16 v[192:195], v[88:91], v[96:99], v[192:195]
    v_mfma_f32_16x16x32_bf16 v[196:199], v[88:91], v[100:103], v[196:199]
    v_mfma_f32_16x16x32_bf16 v[192:195], v[92:95], v[104:107], v[192:195]
    v_mfma_f32_16x16x32_bf16 v[196:199], v[92:95], v[108:111], v[196:199]
    ds_read_b128 v[88:91], v76 offset:8192
    ds_read_b64_tr_b16 v[96:97], v78 offset:5120
    ds_read_b64_tr_b16 v[98:99], v78 offset:5280
    ds_read_b64_tr_b16 v[100:101], v78 offset:5152
    ds_read_b64_tr_b16 v[102:103], v78 offset:5312
    ds_read_b128 v[92:95], v77 offset:8192
    ds_read_b64_tr_b16 v[104:105], v78 offset:6400
    ds_read_b64_tr_b16 v[106:107], v78 offset:6560
    ds_read_b64_tr_b16 v[108:109], v78 offset:6432
    ds_read_b64_tr_b16 v[110:111], v78 offset:6592
    s_waitcnt lgkmcnt(10)
    v_mfma_f32_16x16x32_bf16 v[192:195], v[112:115], v[120:123], v[192:195]
    v_mfma_f32_16x16x32_bf16 v[196:199], v[112:115], v[124:127], v[196:199]
    v_mfma_f32_16x16x32_bf16 v[192:195], v[116:119], v[128:131], v[192:195]
    v_mfma_f32_16x16x32_bf16 v[196:199], v[116:119], v[132:135], v[196:199]
    v_add_u32 v76, 8192, v76
    v_add_u32 v77, 8192, v77
    v_add_u32 v78, 5120, v78
    s_sub_u32 s94, s94, 1
    s_cmp_lg_u32 s94, 0
    s_cbranch_scc1 concat_heads__sliding_block__grouped_kv_mqa__prompt_kernel_t3v
    v_and_b32 v7, 15, v0
    v_lshrrev_b32 v8, 4, v0
    v_and_b32 v11, 1, v8
    v_lshrrev_b32 v10, 1, v8
    s_nop 1
    v_cvt_pk_bf16_f32 v136, v192, v193
    v_cvt_pk_bf16_f32 v137, v194, v195
    v_cvt_pk_bf16_f32 v138, v196, v197
    v_cvt_pk_bf16_f32 v139, v198, v199
    v_mul_u32_u24 v10, 384, v10
    v_lshl_add_u32 v10, v7, 4, v10
    v_lshl_add_u32 v10, v11, 3, v10
    v_lshrrev_b32 v11, 2, v7
    v_lshl_add_u32 v11, v11, 28, v10
    s_mul_i32 s46, s41, 768
    s_add_u32 s46, s46, s45
    buffer_store_dwordx2 v[136:137], v10, s[20:23], s46 offen offset:1280 sc1
    buffer_store_dwordx2 v[138:139], v11, s[20:23], s46 offen offset:1536 sc1
    v_cmp_eq_u32 s[2:3], 0, v7
    v_mov_b32 v8, 0x3f803f80
    s_nop 0
    v_cndmask_b32 v140, 0, v8, s[2:3]
    v_mov_b32 v141, v140
    buffer_store_dwordx2 v[140:141], v11, s[20:23], s46 offen offset:1600 sc1
concat_heads__sliding_block__grouped_kv_mqa__prompt_kernel_t3e:
    s_waitcnt lgkmcnt(0)
    s_setprio 0
    s_waitcnt vmcnt(0)
    s_barrier
    s_barrier
    s_branch concat_heads__sliding_block__grouped_kv_mqa__prompt_kernel_b
concat_heads__sliding_block__grouped_kv_mqa__prompt_kernel_t3l:
    buffer_load_dword v85, off, s[32:35], 0 sc1
    s_waitcnt vmcnt(0)
    s_mov_b32 s3, 0
concat_heads__sliding_block__grouped_kv_mqa__prompt_kernel_spdbg3:
    v_cmp_gt_u32 vcc, 1, v85
    s_add_u32 s3, s3, 1
    s_cbranch_vccz concat_heads__sliding_block__grouped_kv_mqa__prompt_kernel_sddbg3
    s_cmp_gt_u32 s3, 400000
    s_cbranch_scc1 concat_heads__sliding_block__grouped_kv_mqa__prompt_kernel_sddbg3
    s_sleep 1
    buffer_load_dword v85, off, s[32:35], 0  sc1
    s_waitcnt vmcnt(0)
    s_branch concat_heads__sliding_block__grouped_kv_mqa__prompt_kernel_spdbg3
concat_heads__sliding_block__grouped_kv_mqa__prompt_kernel_sddbg3:
    s_barrier
    s_cmp_eq_u32 s36, 4
    s_cbranch_scc0 concat_heads__sliding_block__grouped_kv_mqa__prompt_kernel_t3m
    s_mov_b64 exec, 1
    v_mov_b32 v13, 1
    buffer_store_dword v13, off, s[20:23], s93 sc1
    s_mov_b64 exec, -1
concat_heads__sliding_block__grouped_kv_mqa__prompt_kernel_t3m:
    s_setprio 0
    s_branch concat_heads__sliding_block__grouped_kv_mqa__prompt_kernel_lb0
concat_heads__sliding_block__grouped_kv_mqa__prompt_kernel_slowa:
    s_mov_b32 s101, 1
    s_mov_b32 exec_lo, 0
    v_mov_b32 v28, 0
    v_mov_b32 v29, 0x3f800000
    s_mov_b32 exec_lo, -1
    s_nop 1
    v_mfma_f32_32x32x8bf16_1k v[120:135], v[216:217], v[28:29], v[60:75]
    v_mfma_f32_32x32x16_bf16 v[120:135], v[180:183], v[24:27], v[120:135]
    v_mfma_f32_32x32x8bf16_1k v[136:151], v[218:219], v[28:29], 0
    v_mfma_f32_32x32x16_bf16 v[136:151], v[184:187], v[24:27], v[136:151]
    v_mov_b32 v104, 0
    v_mov_b32 v105, 0
    v_mov_b32 v106, 0
    v_mov_b32 v107, 0
    v_mov_b32 v108, 0
    v_mov_b32 v109, 0
    v_mov_b32 v110, 0
    v_mov_b32 v111, 0
    v_mov_b32 v112, 0
    v_mov_b32 v113, 0
    v_mov_b32 v114, 0
    v_mov_b32 v115, 0
    v_mov_b32 v116, 0
    v_mov_b32 v117, 0
    v_mov_b32 v118, 0
    v_mov_b32 v119, 0
    v_max_f32 v10, v120, v121
    v_max_f32 v11, v122, v123
    v_max3_f32 v10, v124, v125, v10
    v_max3_f32 v11, v126, v127, v11
    v_max3_f32 v10, v128, v129, v10
    v_max3_f32 v11, v130, v131, v11
    v_max3_f32 v10, v132, v133, v10
    v_max3_f32 v11, v134, v135, v11
    v_mfma_f32_32x32x8bf16_1k v[120:135], v[220:221], v[28:29], 0
    v_mfma_f32_32x32x16_bf16 v[120:135], v[188:191], v[24:27], v[120:135]
    s_nop 1
    v_max3_f32 v10, v136, v137, v10
    v_max3_f32 v11, v138, v139, v11
    v_max3_f32 v10, v140, v141, v10
    v_max3_f32 v11, v142, v143, v11
    v_max3_f32 v10, v144, v145, v10
    v_max3_f32 v11, v146, v147, v11
    v_max3_f32 v10, v148, v149, v10
    v_max3_f32 v11, v150, v151, v11
    v_mfma_f32_32x32x8bf16_1k v[136:151], v[222:223], v[28:29], 0
    v_mfma_f32_32x32x16_bf16 v[136:151], v[192:195], v[24:27], v[136:151]
    s_nop 1
    v_max3_f32 v10, v120, v121, v10
    v_max3_f32 v11, v122, v123, v11
    v_max3_f32 v10, v124, v125, v10
    v_max3_f32 v11, v126, v127, v11
    v_max3_f32 v10, v128, v129, v10
    v_max3_f32 v11, v130, v131, v11
    v_max3_f32 v10, v132, v133, v10
    v_max3_f32 v11, v134, v135, v11
    v_mfma_f32_32x32x8bf16_1k v[120:135], v[224:225], v[28:29], 0
    v_mfma_f32_32x32x16_bf16 v[120:135], v[196:199], v[24:27], v[120:135]
    s_nop 1
    v_max3_f32 v10, v136, v137, v10
    v_max3_f32 v11, v138, v139, v11
    v_max3_f32 v10, v140, v141, v10
    v_max3_f32 v11, v142, v143, v11
    v_max3_f32 v10, v144, v145, v10
    v_max3_f32 v11, v146, v147, v11
    v_max3_f32 v10, v148, v149, v10
    v_max3_f32 v11, v150, v151, v11
    v_mfma_f32_32x32x8bf16_1k v[136:151], v[226:227], v[28:29], 0
    v_mfma_f32_32x32x16_bf16 v[136:151], v[200:203], v[24:27], v[136:151]
    s_nop 1
    v_max3_f32 v10, v120, v121, v10
    v_max3_f32 v11, v122, v123, v11
    v_max3_f32 v10, v124, v125, v10
    v_max3_f32 v11, v126, v127, v11
    v_max3_f32 v10, v128, v129, v10
    v_max3_f32 v11, v130, v131, v11
    v_max3_f32 v10, v132, v133, v10
    v_max3_f32 v11, v134, v135, v11
    v_mfma_f32_32x32x8bf16_1k v[120:135], v[228:229], v[28:29], 0
    v_mfma_f32_32x32x16_bf16 v[120:135], v[204:207], v[24:27], v[120:135]
    s_nop 1
    v_max3_f32 v10, v136, v137, v10
    v_max3_f32 v11, v138, v139, v11
    v_max3_f32 v10, v140, v141, v10
    v_max3_f32 v11, v142, v143, v11
    v_max3_f32 v10, v144, v145, v10
    v_max3_f32 v11, v146, v147, v11
    v_max3_f32 v10, v148, v149, v10
    v_max3_f32 v11, v150, v151, v11
    v_mfma_f32_32x32x8bf16_1k v[136:151], v[230:231], v[28:29], 0
    v_mfma_f32_32x32x16_bf16 v[136:151], v[208:211], v[24:27], v[136:151]
    s_nop 1
    v_max3_f32 v10, v120, v121, v10
    v_max3_f32 v11, v122, v123, v11
    v_max3_f32 v10, v124, v125, v10
    v_max3_f32 v11, v126, v127, v11
    v_max3_f32 v10, v128, v129, v10
    v_max3_f32 v11, v130, v131, v11
    v_max3_f32 v10, v132, v133, v10
    v_max3_f32 v11, v134, v135, v11
    v_mfma_f32_32x32x8bf16_1k v[120:135], v[232:233], v[28:29], v[44:59]
    v_mfma_f32_32x32x16_bf16 v[120:135], v[212:215], v[24:27], v[120:135]
    s_nop 1
    v_max3_f32 v10, v136, v137, v10
    v_max3_f32 v11, v138, v139, v11
    v_max3_f32 v10, v140, v141, v10
    v_max3_f32 v11, v142, v143, v11
    v_max3_f32 v10, v144, v145, v10
    v_max3_f32 v11, v146, v147, v11
    v_max3_f32 v10, v148, v149, v10
    v_max3_f32 v11, v150, v151, v11
    s_nop 3
    v_max3_f32 v10, v120, v121, v10
    v_max3_f32 v11, v122, v123, v11
    v_max3_f32 v10, v124, v125, v10
    v_max3_f32 v11, v126, v127, v11
    v_max3_f32 v10, v128, v129, v10
    v_max3_f32 v11, v130, v131, v11
    v_max3_f32 v10, v132, v133, v10
    v_max3_f32 v11, v134, v135, v11
    s_mov_b64 exec, s[62:63]
    ds_read_b128 v[164:167], v20 offset:0
    ds_read_b128 v[168:171], v20 offset:768
    s_mov_b64 exec, -1
    v_max_f32 v10, v10, v11
    v_mov_b32 v11, v10
    s_mov_b32 s2, 0xffff0000
    s_nop 0
    v_permlane32_swap_b32 v10, v11
    s_nop 1
    v_max_f32 v10, v10, v11
    v_xor_b32 v10, 0x80000000, v10
    v_and_b32 v11, s2, v10
    v_sub_f32 v10, v10, v11
    v_and_b32 v12, s2, v10
    v_sub_f32 v10, v10, v12
    v_lshrrev_b32 v11, 16, v11
    v_lshrrev_b32 v10, 16, v10
    s_mov_b32 exec_lo, 0
    v_or_b32 v28, v11, v12
    v_or_b32 v29, 0x3f800000, v10
    s_mov_b32 exec_lo, -1
    s_nop 1
    s_branch concat_heads__sliding_block__grouped_kv_mqa__prompt_kernel_ap2
concat_heads__sliding_block__grouped_kv_mqa__prompt_kernel_slow:
    s_mov_b32 s101, 1
    v_and_b32 v7, 31, v0
    v_lshrrev_b32 v10, 5, v0
    v_lshlrev_b32 v15, 3, v7
    v_mul_u32_u24 v16, 384, v10
    v_min_u32 v7, 23, v7
    v_lshl_add_u32 v16, v7, 4, v16
    s_waitcnt lgkmcnt(0)
    v_mov_b32 v156, 0x3f803f80
    v_mov_b32 v157, 0x3f80
    v_mov_b32 v10, 0xff7fffff
    s_mov_b32 s44, 5767168
concat_heads__sliding_block__grouped_kv_mqa__prompt_kernel_slow1:
    buffer_load_dwordx4 v[152:155], v2, s[20:23], s44 offen sc1
    s_mov_b32 exec_hi, 0
    buffer_load_dwordx2 v[156:157], v15, s[20:23], s44 offen offset:1024 sc1
    s_mov_b32 exec_hi, -1
    s_waitcnt vmcnt(0)
    v_mfma_f32_32x32x8bf16_1k v[120:135], v[156:157], v[34:35], 0
    v_mfma_f32_32x32x16_bf16 v[120:135], v[152:155], v[30:33], v[120:135]
    s_nop 7
    s_nop 3
    v_max3_f32 v10, v120, v121, v10
    v_max3_f32 v10, v122, v123, v10
    v_max3_f32 v10, v124, v125, v10
    v_max3_f32 v10, v126, v127, v10
    v_max3_f32 v10, v128, v129, v10
    v_max3_f32 v10, v130, v131, v10
    v_max3_f32 v10, v132, v133, v10
    v_max3_f32 v10, v134, v135, v10
    s_add_u32 s44, s44, 2816
    s_cmp_lt_u32 s44, 5947392
    s_cbranch_scc1 concat_heads__sliding_block__grouped_kv_mqa__prompt_kernel_slow1
    v_mov_b32 v11, v10
    s_mov_b32 s2, 0xffff0000
    s_nop 0
    v_permlane32_swap_b32 v10, v11
    s_nop 1
    v_max_f32 v10, v10, v11
    v_xor_b32 v10, 0x80000000, v10
    v_and_b32 v11, s2, v10
    v_sub_f32 v10, v10, v11
    v_and_b32 v12, s2, v10
    v_sub_f32 v10, v10, v12
    v_lshrrev_b32 v11, 16, v11
    v_lshrrev_b32 v10, 16, v10
    s_mov_b32 exec_lo, 0
    v_or_b32 v34, v11, v12
    v_or_b32 v35, 0, v10
    s_mov_b32 exec_lo, -1
    s_nop 1
    v_mov_b32 v88, 0
    v_mov_b32 v89, 0
    v_mov_b32 v90, 0
    v_mov_b32 v91, 0
    v_mov_b32 v92, 0
    v_mov_b32 v93, 0
    v_mov_b32 v94, 0
    v_mov_b32 v95, 0
    v_mov_b32 v96, 0
    v_mov_b32 v97, 0
    v_mov_b32 v98, 0
    v_mov_b32 v99, 0
    v_mov_b32 v100, 0
    v_mov_b32 v101, 0
    v_mov_b32 v102, 0
    v_mov_b32 v103, 0
    s_mov_b32 s44, 5767168
concat_heads__sliding_block__grouped_kv_mqa__prompt_kernel_slow2:
    buffer_load_dwordx4 v[152:155], v2, s[20:23], s44 offen sc1
    s_mov_b32 exec_hi, 0
    buffer_load_dwordx2 v[156:157], v15, s[20:23], s44 offen offset:1024 sc1
    s_mov_b64 exec, -1
    buffer_load_dwordx4 v[164:167], v16, s[20:23], s44 offen offset:1280 sc1
    buffer_load_dwordx4 v[168:171], v16, s[20:23], s44 offen offset:2048 sc1
    s_mov_b64 exec, -1
    s_waitcnt vmcnt(0)
    v_mfma_f32_32x32x8bf16_1k v[120:135], v[156:157], v[34:35], 0
    v_mfma_f32_32x32x16_bf16 v[120:135], v[152:155], v[30:33], v[120:135]
    s_nop 7
    s_nop 3
    v_exp_f32 v120, v120
    v_exp_f32 v121, v121
    v_exp_f32 v122, v122
    v_exp_f32 v123, v123
    v_exp_f32 v124, v124
    v_exp_f32 v125, v125
    v_exp_f32 v126, v126
    v_exp_f32 v127, v127
    v_exp_f32 v128, v128
    v_exp_f32 v129, v129
    v_exp_f32 v130, v130
    v_exp_f32 v131, v131
    v_exp_f32 v132, v132
    v_exp_f32 v133, v133
    v_exp_f32 v134, v134
    v_exp_f32 v135, v135
    s_nop 1
    v_smfmac_f32_32x32x32_bf16 v[88:103], v[164:167], v[120:127], v1
    v_smfmac_f32_32x32x32_bf16 v[88:103], v[168:171], v[128:135], v1
    s_add_u32 s44, s44, 2816
    s_cmp_lt_u32 s44, 5947392
    s_cbranch_scc1 concat_heads__sliding_block__grouped_kv_mqa__prompt_kernel_slow2
    s_nop 7
    s_nop 3
    v_mfma_f32_32x32x8bf16_1k v[120:135], v[216:217], v[28:29], v[60:75]
    v_mfma_f32_32x32x16_bf16 v[120:135], v[180:183], v[24:27], v[120:135]
    s_mov_b64 exec, s[62:63]
    ds_read_b128 v[164:167], v20 offset:0
    ds_read_b128 v[168:171], v20 offset:768
    s_mov_b64 exec, -1
    s_branch concat_heads__sliding_block__grouped_kv_mqa__prompt_kernel_fin
concat_heads__sliding_block__grouped_kv_mqa__prompt_kernel_last:
    s_endpgm
.section .rodata,"a"
.p2align 6
.amdhsa_kernel concat_heads__sliding_block__grouped_kv_mqa__prompt_kernel
  .amdhsa_next_free_vgpr 256
  .amdhsa_next_free_sgpr 102
  .amdhsa_accum_offset 256
  .amdhsa_group_segment_fixed_size 0
  .amdhsa_kernarg_size 88
  .amdhsa_user_sgpr_count 2
  .amdhsa_user_sgpr_kernarg_segment_ptr 1
  .amdhsa_system_sgpr_workgroup_id_x 1
.end_amdhsa_kernel
```
